```python
import torch

def _softmax(x, axis=-1):
    return torch.softmax(x, dim=axis)
def _gelu(x):
    return torch.nn.functional.gelu(x, approximate="tanh")
def _silu(x):
    return torch.nn.functional.silu(x)
def _sigmoid(x):
    return torch.sigmoid(x)
def _layernorm(x, axis=-1, eps=1e-5):
    m = x.mean(dim=axis, keepdim=True)
    v = x.var(dim=axis, keepdim=True, unbiased=False)
    return (x - m) / torch.sqrt(v + eps)
def _scatter_add(tgt, idx, src, axis=0):
    return tgt.clone().index_add_(axis, idx, src)
def _segment_sum(src, seg, n):
    out = torch.zeros((n,) + src.shape[1:], dtype=src.dtype)
    return out.index_add_(0, seg, src)
def _pad(x, pw):
    flat = tuple(v for pair in reversed(pw) for v in pair)
    return torch.nn.functional.pad(x, flat)

kernel_name = 'gather_scatter__cheap_equivariant_egnn__graph'

def setup_inputs():

    _w = (lambda a: (lambda t: t.to(torch.bfloat16) if t.is_floating_point() else t)(torch.as_tensor(a)))
    N, deg, D, De = 25000, 16, 128, max(0, 1)
    E = N * deg
    return {
        "h": _w((lambda *s: torch.randn(*s, dtype=torch.bfloat16) * 0.2)(N, D)),
        "pos": _w((lambda *s: torch.randn(*s, dtype=torch.bfloat16) * 0.8)(N, 3)),
        "e_attr": _w((lambda *s: torch.randn(*s, dtype=torch.bfloat16) * 0.8)(E, De)),
        "src": _w((lambda lo, hi, *s: torch.randint(lo, hi, s))(0, N, E).to(torch.int64)),
        "dst": _w((lambda lo, hi, *s: torch.randint(lo, hi, s))(0, N, E).to(torch.int64)),
        "w_e": _w(0.1 * (lambda *s: torch.randn(*s, dtype=torch.bfloat16) * 0.8)(2 * D + 1 + De, D)),
        "w_x": _w(0.1 * (lambda *s: torch.randn(*s, dtype=torch.bfloat16) * 0.2)(D, 1)),
        "w_h": _w(0.1 * (lambda *s: torch.randn(*s, dtype=torch.bfloat16) * 0.2)(2 * D, D)),
    }

def reference(h, pos, e_attr, src, dst, w_e, w_x, w_h):
    N, D = h.shape[0], h.shape[1]
    diff = pos[dst] - pos[src]
    dist2 = torch.sum(diff * diff, axis=-1, keepdims=True)
    e_in = torch.concatenate([h[dst], h[src], dist2, e_attr], axis=-1)
    m_ij = _silu(e_in @ w_e)
    coord_scale = m_ij @ w_x
    pos_new = pos + _segment_sum(diff * coord_scale, dst, N)
    m_i = _segment_sum(m_ij, dst, N)
    h_new = h + _silu(torch.concatenate([h, m_i], axis=-1) @ w_h)
    return h_new, pos_new
```

```asm
; @launch grid=(256,1,1) block=(512,1,1) lds=162176
.amdgcn_target "amdgcn-amd-amdhsa--gfx950"
.text
.p2align 8
.globl gather_scatter__cheap_equivariant_egnn__graph_kernel
.type gather_scatter__cheap_equivariant_egnn__graph_kernel,@function
gather_scatter__cheap_equivariant_egnn__graph_kernel:
    s_cmp_lt_u32 s2, 256
    s_cbranch_scc1 K_GO
    s_endpgm
K_GO:
    s_load_dwordx16 s[64:79], s[0:1], 0
    s_load_dwordx4 s[36:39], s[0:1], 64
    s_load_dwordx2 s[40:41], s[0:1], 80
    s_memrealtime s[42:43]
    s_getpc_b64 s[4:5]
    v_lshlrev_b32 v2, 7, v0
    v_mov_b32 v3, 0
    s_mov_b32 s3, (K2_END-K_NOCPF)/128
    v_lshl_add_u64 v[2:3], v[2:3], 0, s[4:5]
    v_cmp_gt_u32 vcc, s3, v0
    s_and_saveexec_b64 s[6:7], vcc
    s_cbranch_execz K_NOCPF
    global_load_dword v63, v[2:3], off
K_NOCPF:
    s_mov_b64 exec, -1
    v_mov_b32 v254, v0
    v_lshrrev_b32 v1, 6, v0
    v_and_b32 v250, 63, v0
    v_readfirstlane_b32 s25, v1
    s_and_b32 s3, s2, 7
    s_lshl_b32 s3, s3, 5
    s_lshr_b32 s24, s2, 3
    s_add_u32 s24, s24, s3
    s_mul_i32 s86, s24, 98
    s_sub_u32 s3, 25000, s86
    s_min_u32 s87, s3, 98
    v_lshrrev_b32 v2, 4, v250
    v_and_b32 v3, 15, v250
    s_and_b32 s3, s25, 3
    s_lshl_b32 s3, s3, 2
    v_add_u32 v4, s3, v2
    v_xor_b32 v4, v4, v3
    v_lshlrev_b32 v5, 8, v2
    v_lshl_add_u32 v234, v4, 4, v5
    v_lshlrev_b32 v4, 2, v2
    v_xor_b32 v4, v4, v3
    v_lshl_add_u32 v235, v4, 4, v5
    v_and_b32 v4, 1, v2
    v_xor_b32 v4, v4, v3
    v_lshl_add_u32 v236, v4, 4, v5
    v_lshlrev_b32 v237, 4, v250
    s_mul_i32 s3, s2, 1564
    v_lshl_add_u32 v6, v254, 2, s3
    s_mov_b32 s3, 400000
    v_cmp_gt_u32 s[60:61], s3, v6
    s_movk_i32 s3, 391
    v_cmp_gt_u32 vcc, s3, v254
    v_bfrev_b32 v7, 1
    v_lshlrev_b32 v238, 2, v6
    s_and_b64 s[60:61], s[60:61], vcc
    v_lshlrev_b32 v239, 1, v6
    v_mov_b64 v[8:9], 0
    v_mov_b64 v[10:11], 0
    v_add_u32 v12, 112000, v237
    v_cndmask_b32_e64 v238, v7, v238, s[60:61]
    v_cndmask_b32_e64 v239, v7, v239, s[60:61]
    s_lshl_b32 s82, s86, 8
    s_lshl_b32 s83, s87, 8
    s_lshl_b32 s84, s25, 10
    s_waitcnt lgkmcnt(0)
    s_mov_b32 s4, s72
    s_mov_b32 s5, s73
    s_mov_b32 s6, 1600000
    s_mov_b32 s7, 0x20000
    s_mov_b32 s8, s70
    s_mov_b32 s9, s71
    s_mov_b32 s10, 1600000
    s_mov_b32 s11, 0x20000
    buffer_load_dwordx4 v[128:131], v238, s[4:7], 0 offen nt
    ds_write_b128 v12, v[8:11]
    buffer_load_dwordx4 v[132:135], v238, s[8:11], 0 offen nt
    s_mov_b32 s44, s68
    s_mov_b32 s45, s69
    s_mov_b32 s46, 800000
    s_mov_b32 s47, 0x20000
    s_mov_b32 s96, s38
    s_mov_b32 s97, s39
    s_mov_b32 s98, 8
    s_mov_b32 s99, 0x20000
    buffer_load_dwordx2 v[136:137], v239, s[44:47], 0 offen nt
    s_lshl_b32 s3, s43, 22
    s_or_b32 s3, s3, 1
    v_mov_b32 v14, s42
    v_mov_b32 v15, s3
    s_or_b32 s3, s2, s25
    s_cmp_eq_u32 s3, 0
    s_cselect_b32 s98, 8, 0
    buffer_store_dwordx2 v[14:15], v237, s[96:99], 0 offen sc1
    v_lshlrev_b32 v13, 2, v250
    ds_write_b32 v13, v8 offset:0
    ds_write_b32 v13, v8 offset:64
    s_add_u32 s16, s64, s82
    s_addc_u32 s17, s65, 0
    s_mov_b32 s18, s83
    s_mov_b32 s19, 0x20000
    s_mov_b32 s20, s74
    s_mov_b32 s21, s75
    s_mov_b32 s22, 66052
    s_mov_b32 s23, 0x20000
    s_mov_b32 s98, 8
    s_cmp_eq_u32 s25, 7
    s_cbranch_scc0 K_NOPF0
    v_lshlrev_b32 v186, 7, v250
    s_lshr_b32 s3, s2, 3
    s_lshl_b32 s3, s3, 11
    s_mov_b64 exec, 0xffff
    buffer_load_dword v187, v186, s[20:23], s3 offen
    s_mov_b64 exec, -1
K_NOPF0:
    s_waitcnt lgkmcnt(0)
    s_barrier
    s_lshl_b32 s94, s25, 10
    s_add_u32 m0, s94, 53632
    s_add_u32 s3, s94, 0
    buffer_load_dwordx4 v234, s[16:19], s3 offen nt lds
    s_add_u32 m0, s94, 61824
    s_add_u32 s3, s94, 8192
    buffer_load_dwordx4 v234, s[16:19], s3 offen nt lds
    s_add_u32 m0, s94, 70016
    s_add_u32 s3, s94, 16384
    buffer_load_dwordx4 v234, s[16:19], s3 offen nt lds
    s_add_u32 s94, s94, 34656
    s_lshl_b32 s3, s25, 12
    s_add_u32 s3, s3, 24576
    s_cmp_eq_u32 s25, 0
    s_cselect_b32 m0, 78208, s94
    v_mov_b32 v190, v237
    buffer_load_dwordx4 v234, s[16:19], s3 offen nt lds
    v_add_u32 v191, 53632, v237
    v_mov_b32 v234, 0
    s_mov_b32 s26, 0
    s_mov_b32 s95, 0
    s_mov_b32 s27, 0
    s_mov_b32 s28, 0
    s_mov_b32 s29, 0
    s_mov_b32 s62, 0x11111111
    s_mov_b32 s63, 0x11111
    s_mov_b32 s80, 0xbfb8aa3b
    s_mov_b32 s81, 0xbfb8aa3b
    v_and_b32 v8, 31, v250
    v_lshrrev_b32 v9, 5, v250
    v_and_b32 v10, 3, v250
    v_bfe_u32 v11, v250, 2, 2
    v_and_b32 v13, 1, v2
    s_lshr_b32 s82, s25, 1
    s_lshl_b32 s82, s82, 5
    s_min_u32 s82, s82, 81
    s_and_b32 s83, s25, 1
    v_add_u32 v5, s82, v8
    v_and_b32 v4, 15, v5
    v_xor_b32 v4, v9, v4
    v_lshlrev_b32 v4, 4, v4
    v_lshl_add_u32 v240, v5, 8, v4
    v_lshlrev_b32 v4, 5, v13
    v_lshl_add_u32 v4, v10, 3, v4
    v_lshl_add_u32 v4, v11, 8, v4
    s_lshl_b32 s3, s83, 1
    v_xor_b32 v5, s3, v11
    v_lshl_add_u32 v247, v5, 6, v4
    v_lshl_add_u32 v242, v9, 11, v247
    v_xor_b32 v243, 64, v242
    v_lshl_add_u32 v4, v9, 3, v11
    v_lshlrev_b32 v4, 8, v4
    v_lshl_add_u32 v4, v13, 7, v4
    v_lshl_add_u32 v4, v10, 5, v4
    v_and_b32 v5, 1, v11
    v_xor_b32 v5, s83, v5
    v_lshl_add_u32 v4, v5, 4, v4
    v_add_u32 v244, 129408, v4
    v_lshlrev_b32 v217, 4, v10
    v_lshl_add_u32 v217, v9, 6, v217
    v_lshlrev_b32 v222, 4, v8
    v_add_u32 v222, 1888, v222
    v_mov_b32 v223, v222
    v_mov_b32 v218, v222
    v_bfe_u32 v4, v250, 2, 1
    v_bfe_u32 v5, v250, 3, 2
    v_lshl_add_u32 v251, v4, 2, v5
    s_lshl_b32 s3, s25, 9
    s_add_u32 s3, s3, 105376
    v_lshl_add_u32 v225, v251, 2, s3
    v_lshl_add_u32 v230, v250, 2, s3
    s_add_u32 s3, s3, 256
    v_lshl_add_u32 v226, v9, 4, s3
    s_lshl_b32 s3, s25, 12
    s_add_u32 s3, s3, 129408
    v_lshl_add_u32 v228, v250, 6, s3
    v_lshl_add_u32 v5, v9, 2, v11
    v_lshl_add_u32 v227, v5, 6, s3
    v_lshl_add_u32 v227, v13, 5, v227
    v_lshl_add_u32 v227, v10, 3, v227
    v_mul_u32_u24 v231, 528, v9
    v_lshl_add_u32 v231, v8, 2, v231
    v_add_u32 v231, 53632, v231
    v_bfe_u32 v5, v250, 3, 1
    v_lshl_add_u32 v5, v5, 1, v13
    v_lshl_add_u32 v5, v5, 1, v9
    v_lshlrev_b32 v6, 2, v4
    v_lshl_add_u32 v232, v5, 4, v6
    v_add_u32 v232, 109472, v232
    v_lshlrev_b32 v5, 1, v9
    v_cmp_eq_u32 s[56:57], v10, v5
    v_add_u32 v5, 1, v5
    v_cmp_eq_u32 s[58:59], v10, v5
    v_cmp_eq_u32 vcc, v4, v9
    v_lshl_add_u32 v5, v13, 2, v10
    v_bfe_u32 v6, v250, 3, 1
    v_cndmask_b32_e64 v5, 64, v5, vcc
    v_lshlrev_b32 v6, 4, v6
    v_mov_b32 v12, 0x3f80
    v_lshlrev_b32 v6, v6, v12
    v_cmp_eq_u32 vcc, 0, v5
    v_cmp_eq_u32 s[84:85], 1, v5
    s_nop 0
    v_cndmask_b32_e64 v200, 0, v6, vcc
    v_cndmask_b32_e64 v201, 0, v6, s[84:85]
    v_cmp_eq_u32 vcc, 2, v5
    v_cmp_eq_u32 s[84:85], 3, v5
    s_nop 0
    v_cndmask_b32_e64 v202, 0, v6, vcc
    v_cndmask_b32_e64 v203, 0, v6, s[84:85]
    v_cmp_eq_u32 vcc, 4, v5
    v_cmp_eq_u32 s[84:85], 5, v5
    s_nop 0
    v_cndmask_b32_e64 v204, 0, v6, vcc
    v_cndmask_b32_e64 v205, 0, v6, s[84:85]
    v_cmp_eq_u32 vcc, 6, v5
    v_cmp_eq_u32 s[84:85], 7, v5
    s_nop 0
    v_cndmask_b32_e64 v206, 0, v6, vcc
    v_cndmask_b32_e64 v207, 0, v6, s[84:85]
    s_lshl_b32 s3, s82, 8
    s_lshl_b32 s84, s83, 7
    s_add_u32 s3, s3, s84
    v_lshlrev_b32 v4, 10, v9
    v_lshl_add_u32 v4, v8, 2, v4
    v_add_u32 v245, s3, v4
    s_mul_i32 s3, s82, 528
    s_lshl_b32 s84, s83, 3
    s_add_u32 s3, s3, s84
    v_mul_u32_u24 v4, 2112, v9
    v_lshl_add_u32 v4, v8, 4, v4
    v_add_u32 v246, s3, v4
    v_lshrrev_b32 v4, 2, v8
    v_lshlrev_b32 v4, 5, v4
    v_lshl_add_u32 v249, v10, 1, v4
    v_lshl_add_u32 v248, v9, 4, v249
    s_mov_b32 s8, s66
    s_mov_b32 s9, s67
    s_mov_b32 s10, 150000
    s_mov_b32 s11, 0x20000
    s_mov_b32 s4, s78
    s_mov_b32 s5, s79
    s_mov_b32 s6, 65536
    s_mov_b32 s7, 0x20000
    s_mov_b32 s44, s76
    s_mov_b32 s45, s77
    s_mov_b32 s46, 256
    s_mov_b32 s47, 0x20000
    s_cmp_eq_u32 s25, 7
    s_cbranch_scc0 K_NOSM
    s_mov_b32 m0, 42848
    s_mov_b32 s3, 65536
    buffer_load_dwordx4 v237, s[20:23], s3 offen lds
    s_mov_b32 m0, 43360
    s_mul_i32 s3, s86, 6
    buffer_load_dwordx4 v237, s[44:47], 0 offen lds
    s_mov_b32 m0, 43616
    v_lshlrev_b32 v186, 7, v250
    buffer_load_dwordx4 v237, s[8:11], s3 offen lds
    s_lshr_b32 s85, s2, 3
    s_lshl_b32 s3, s85, 11
    s_mul_i32 s85, s85, 4736
    s_mov_b64 exec, 0xffff
    buffer_load_dword v187, v186, s[4:7], s3 offen
    s_mov_b32 exec_lo, -1
    s_mov_b32 exec_hi, 31
    buffer_load_dword v187, v186, s[8:11], s85 offen
    s_mov_b64 exec, -1
    v_mov_b32 v155, 0
    v_mov_b64 v[138:139], 0
    v_mov_b64 v[140:141], 0
    buffer_load_dwordx2 v[252:253], v155, s[96:99], 0 offen sc1
    v_add_u32 v155, 112000, v237
    s_branch K_BARB
K_NOSM:
    s_movk_i32 s84, 21400
    s_movk_i32 s85, -98
    v_mov_b32 v154, 1
    v_mov_b32 v155, 0
    s_waitcnt vmcnt(7)
    v_mul_u32_u24 v138, s84, v128
    v_lshrrev_b32 v138, 21, v138
    v_mul_u32_u24 v139, s84, v129
    v_lshrrev_b32 v139, 21, v139
    v_mul_u32_u24 v140, s84, v130
    v_lshrrev_b32 v140, 21, v140
    v_mul_u32_u24 v141, s84, v131
    v_lshrrev_b32 v141, 21, v141
    v_mad_i32_i24 v128, v138, s85, v128
    v_lshlrev_b32 v138, 2, v138
    v_add_u32 v138, 112000, v138
    v_mad_i32_i24 v129, v139, s85, v129
    v_lshlrev_b32 v139, 2, v139
    v_add_u32 v139, 112000, v139
    v_mad_i32_i24 v130, v140, s85, v130
    v_lshlrev_b32 v140, 2, v140
    v_add_u32 v140, 112000, v140
    v_mad_i32_i24 v131, v141, s85, v131
    v_lshlrev_b32 v141, 2, v141
    v_add_u32 v141, 112000, v141
    s_mov_b64 exec, s[60:61]
    ds_add_rtn_u32 v142, v138, v154
    ds_add_rtn_u32 v143, v139, v154
    ds_add_rtn_u32 v144, v140, v154
    ds_add_rtn_u32 v145, v141, v154
    s_mov_b64 exec, -1
    buffer_load_dwordx2 v[252:253], v155, s[96:99], 0 offen sc1
    v_add_u32 v155, 112000, v237
    s_waitcnt vmcnt(6)
    v_lshl_or_b32 v146, v128, 16, v132
    v_lshlrev_b32 v128, 1, v128
    v_and_b32 v128, 0xf0, v128
    v_lshl_or_b32 v148, v129, 16, v133
    v_lshlrev_b32 v129, 1, v129
    v_and_b32 v129, 0xf0, v129
    v_lshl_or_b32 v150, v130, 16, v134
    v_lshlrev_b32 v130, 1, v130
    v_and_b32 v130, 0xf0, v130
    v_lshl_or_b32 v152, v131, 16, v135
    v_lshlrev_b32 v131, 1, v131
    v_and_b32 v131, 0xf0, v131
    s_mov_b32 s3, 0xffff0000
    v_lshl_or_b32 v147, v136, 16, v128
    v_and_or_b32 v149, v136, s3, v129
    v_lshl_or_b32 v151, v137, 16, v130
    v_and_or_b32 v153, v137, s3, v131
K_BARB:
    s_waitcnt lgkmcnt(0)
    s_barrier
    ds_read_b128 v[156:159], v155
    s_add_u32 s12, s40, 6553600
    s_addc_u32 s13, s41, 0
    s_mov_b32 s14, 3866624
    s_mov_b32 s15, 0x20000
    s_waitcnt lgkmcnt(0)
    v_add_u32 v160, v156, v157
    v_add3_u32 v162, v160, v158, v159
    v_add_u32 v161, v160, v158
    v_mov_b32 v163, v162
    s_nop 1
    v_add_u32_dpp v163, v163, v163 row_shr:1 row_mask:0xf bank_mask:0xf
    s_nop 1
    v_add_u32_dpp v163, v163, v163 row_shr:2 row_mask:0xf bank_mask:0xf
    s_nop 1
    v_add_u32_dpp v163, v163, v163 row_shr:4 row_mask:0xf bank_mask:0xf
    s_nop 1
    v_add_u32_dpp v163, v163, v163 row_shr:8 row_mask:0xf bank_mask:0xf
    s_nop 1
    v_add_u32_dpp v163, v163, v163 row_bcast:15 row_mask:0xa bank_mask:0xf
    s_nop 1
    v_add_u32_dpp v163, v163, v163 row_bcast:31 row_mask:0xc bank_mask:0xf
    s_nop 1
    v_sub_u32 v164, v163, v162
    v_add_u32 v165, v164, v156
    v_add_u32 v166, v164, v160
    v_add_u32 v167, v164, v161
    ds_write_b128 v155, v[164:167] offset:1024
    ds_read_b32 v128, v138 offset:1024
    ds_read_b32 v129, v139 offset:1024
    ds_read_b32 v130, v140 offset:1024
    ds_read_b32 v131, v141 offset:1024
    s_mov_b32 s3, 114048
    s_waitcnt lgkmcnt(0)
    v_add_u32 v128, v128, v142
    v_lshl_add_u32 v128, v128, 3, s3
    v_add_u32 v129, v129, v143
    v_lshl_add_u32 v129, v129, 3, s3
    v_add_u32 v130, v130, v144
    v_lshl_add_u32 v130, v130, 3, s3
    v_add_u32 v131, v131, v145
    v_lshl_add_u32 v131, v131, 3, s3
    s_mov_b64 exec, s[60:61]
    ds_write_b64 v128, v[146:147]
    ds_write_b64 v129, v[148:149]
    ds_write_b64 v130, v[150:151]
    ds_write_b64 v131, v[152:153]
    s_mov_b64 exec, -1
    s_lshl_b32 s94, s25, 10
    s_add_u32 m0, s94, 1888
    s_add_u32 s3, s94, 32768
    buffer_load_dwordx4 v235, s[20:23], s3 offen lds
    s_add_u32 m0, s94, 10080
    s_add_u32 s3, s94, 40960
    buffer_load_dwordx4 v235, s[20:23], s3 offen lds
    s_add_u32 m0, s94, 18272
    s_add_u32 s3, s94, 49152
    buffer_load_dwordx4 v235, s[20:23], s3 offen lds
    s_add_u32 m0, s94, 26464
    s_add_u32 s3, s94, 57344
    buffer_load_dwordx4 v235, s[20:23], s3 offen lds
    s_waitcnt lgkmcnt(0)
    s_barrier
    s_cmp_eq_u32 s25, 6
    s_cbranch_scc0 K_NOROUT
    s_mul_i32 s82, s2, 12544
    s_add_u32 s82, s82, 6553600
    s_add_u32 s44, s40, s82
    s_addc_u32 s45, s41, 0
    s_mov_b32 s46, 12544
    s_mov_b32 s47, 0x20000
    v_add_u32 v238, 114048, v237
    ds_read_b128 v[64:67], v238 offset:0
    ds_read_b128 v[68:71], v238 offset:1024
    ds_read_b128 v[72:75], v238 offset:2048
    ds_read_b128 v[76:79], v238 offset:3072
    ds_read_b128 v[80:83], v238 offset:4096
    ds_read_b128 v[84:87], v238 offset:5120
    ds_read_b128 v[88:91], v238 offset:6144
    ds_read_b128 v[92:95], v238 offset:7168
    ds_read_b128 v[96:99], v238 offset:8192
    ds_read_b128 v[100:103], v238 offset:9216
    ds_read_b128 v[104:107], v238 offset:10240
    ds_read_b128 v[108:111], v238 offset:11264
    ds_read_b128 v[112:115], v238 offset:12288
    s_mov_b32 s3, 0
    s_waitcnt lgkmcnt(12)
    buffer_store_dwordx4 v[64:67], v237, s[44:47], s3 offen offset:0 sc1
    s_waitcnt lgkmcnt(11)
    buffer_store_dwordx4 v[68:71], v237, s[44:47], s3 offen offset:1024 sc1
    s_waitcnt lgkmcnt(10)
    buffer_store_dwordx4 v[72:75], v237, s[44:47], s3 offen offset:2048 sc1
    s_waitcnt lgkmcnt(9)
    buffer_store_dwordx4 v[76:79], v237, s[44:47], s3 offen offset:3072 sc1
    s_add_u32 s3, s3, 4096
    s_waitcnt lgkmcnt(8)
    buffer_store_dwordx4 v[80:83], v237, s[44:47], s3 offen offset:0 sc1
    s_waitcnt lgkmcnt(7)
    buffer_store_dwordx4 v[84:87], v237, s[44:47], s3 offen offset:1024 sc1
    s_waitcnt lgkmcnt(6)
    buffer_store_dwordx4 v[88:91], v237, s[44:47], s3 offen offset:2048 sc1
    s_waitcnt lgkmcnt(5)
    buffer_store_dwordx4 v[92:95], v237, s[44:47], s3 offen offset:3072 sc1
    s_add_u32 s3, s3, 4096
    s_waitcnt lgkmcnt(4)
    buffer_store_dwordx4 v[96:99], v237, s[44:47], s3 offen offset:0 sc1
    s_waitcnt lgkmcnt(3)
    buffer_store_dwordx4 v[100:103], v237, s[44:47], s3 offen offset:1024 sc1
    s_waitcnt lgkmcnt(2)
    buffer_store_dwordx4 v[104:107], v237, s[44:47], s3 offen offset:2048 sc1
    s_waitcnt lgkmcnt(1)
    buffer_store_dwordx4 v[108:111], v237, s[44:47], s3 offen offset:3072 sc1
    s_add_u32 s3, s3, 4096
    s_waitcnt lgkmcnt(0)
    buffer_store_dwordx4 v[112:115], v237, s[44:47], s3 offen offset:0 sc1
    s_waitcnt vmcnt(13)
    s_branch K_HOK
K_NOROUT:
    s_cmp_eq_u32 s25, 7
    s_cbranch_scc0 K_NOL2A
    s_call_b64 s[54:55], K_LOADS2
    s_waitcnt vmcnt(8)
    s_branch K_HOK
K_NOL2A:
    s_waitcnt vmcnt(0)
K_HOK:
    s_barrier
    v_readfirstlane_b32 s42, v252
    v_readfirstlane_b32 s43, v253
K_TAG:
    s_cmp_lg_u32 s43, 0
    s_cbranch_scc1 K_TAGOK
    s_add_u32 s95, s95, 1
    s_cmp_gt_u32 s95, 200000
    s_cbranch_scc1 K_TAGOK
    buffer_load_dwordx2 v[252:253], v234, s[96:99], 0 offen sc1
    s_waitcnt vmcnt(0)
    v_readfirstlane_b32 s42, v252
    v_readfirstlane_b32 s43, v253
    s_branch K_TAG
K_TAGOK:
    s_and_b32 s43, s43, 0xffc00000
    ds_read_b128 v[0:3], v240 offset:53632
    ds_read_b64_tr_b16 v[32:33], v242 offset:1888
    ds_read_b64_tr_b16 v[34:35], v242 offset:2912
    ds_read_b64_tr_b16 v[36:37], v243 offset:1888
    ds_read_b64_tr_b16 v[38:39], v243 offset:2912
    v_xor_b32 v155, 32, v240
    ds_read_b128 v[4:7], v155 offset:53632
    ds_read_b64_tr_b16 v[40:41], v242 offset:5984
    ds_read_b64_tr_b16 v[42:43], v242 offset:7008
    ds_read_b64_tr_b16 v[44:45], v243 offset:5984
    ds_read_b64_tr_b16 v[46:47], v243 offset:7008
    v_xor_b32 v155, 64, v240
    ds_read_b128 v[8:11], v155 offset:53632
    ds_read_b64_tr_b16 v[48:49], v242 offset:10080
    ds_read_b64_tr_b16 v[50:51], v242 offset:11104
    ds_read_b64_tr_b16 v[52:53], v243 offset:10080
    ds_read_b64_tr_b16 v[54:55], v243 offset:11104
    s_waitcnt lgkmcnt(10)
    v_mfma_f32_32x32x16_bf16 v[96:111], v[0:3], v[32:35], 0
    v_mfma_f32_32x32x16_bf16 v[112:127], v[0:3], v[36:39], 0
    v_xor_b32 v155, 96, v240
    ds_read_b128 v[12:15], v155 offset:53632
    ds_read_b64_tr_b16 v[56:57], v242 offset:14176
    ds_read_b64_tr_b16 v[58:59], v242 offset:15200
    ds_read_b64_tr_b16 v[60:61], v243 offset:14176
    ds_read_b64_tr_b16 v[62:63], v243 offset:15200
    s_waitcnt lgkmcnt(10)
    v_mfma_f32_32x32x16_bf16 v[96:111], v[4:7], v[40:43], v[96:111]
    v_mfma_f32_32x32x16_bf16 v[112:127], v[4:7], v[44:47], v[112:127]
    v_xor_b32 v155, 128, v240
    ds_read_b128 v[16:19], v155 offset:53632
    ds_read_b64_tr_b16 v[32:33], v242 offset:18272
    ds_read_b64_tr_b16 v[34:35], v242 offset:19296
    ds_read_b64_tr_b16 v[36:37], v243 offset:18272
    ds_read_b64_tr_b16 v[38:39], v243 offset:19296
    s_waitcnt lgkmcnt(10)
    v_mfma_f32_32x32x16_bf16 v[96:111], v[8:11], v[48:51], v[96:111]
    v_mfma_f32_32x32x16_bf16 v[112:127], v[8:11], v[52:55], v[112:127]
    v_xor_b32 v155, 160, v240
    ds_read_b128 v[20:23], v155 offset:53632
    ds_read_b64_tr_b16 v[40:41], v242 offset:22368
    ds_read_b64_tr_b16 v[42:43], v242 offset:23392
    ds_read_b64_tr_b16 v[44:45], v243 offset:22368
    ds_read_b64_tr_b16 v[46:47], v243 offset:23392
    s_waitcnt lgkmcnt(10)
    v_mfma_f32_32x32x16_bf16 v[96:111], v[12:15], v[56:59], v[96:111]
    v_mfma_f32_32x32x16_bf16 v[112:127], v[12:15], v[60:63], v[112:127]
    v_xor_b32 v155, 192, v240
    ds_read_b128 v[24:27], v155 offset:53632
    ds_read_b64_tr_b16 v[48:49], v242 offset:26464
    ds_read_b64_tr_b16 v[50:51], v242 offset:27488
    ds_read_b64_tr_b16 v[52:53], v243 offset:26464
    ds_read_b64_tr_b16 v[54:55], v243 offset:27488
    s_waitcnt lgkmcnt(10)
    v_mfma_f32_32x32x16_bf16 v[96:111], v[16:19], v[32:35], v[96:111]
    v_mfma_f32_32x32x16_bf16 v[112:127], v[16:19], v[36:39], v[112:127]
    v_xor_b32 v155, 224, v240
    ds_read_b128 v[28:31], v155 offset:53632
    ds_read_b64_tr_b16 v[56:57], v242 offset:30560
    ds_read_b64_tr_b16 v[58:59], v242 offset:31584
    ds_read_b64_tr_b16 v[60:61], v243 offset:30560
    ds_read_b64_tr_b16 v[62:63], v243 offset:31584
    s_waitcnt lgkmcnt(10)
    v_mfma_f32_32x32x16_bf16 v[96:111], v[20:23], v[40:43], v[96:111]
    v_mfma_f32_32x32x16_bf16 v[112:127], v[20:23], v[44:47], v[112:127]
    s_waitcnt lgkmcnt(5)
    v_mfma_f32_32x32x16_bf16 v[96:111], v[24:27], v[48:51], v[96:111]
    v_mfma_f32_32x32x16_bf16 v[112:127], v[24:27], v[52:55], v[112:127]
    s_waitcnt lgkmcnt(0)
    s_barrier
    v_mfma_f32_32x32x16_bf16 v[96:111], v[28:31], v[56:59], v[96:111]
    v_mfma_f32_32x32x16_bf16 v[112:127], v[28:31], v[60:63], v[112:127]
    s_cmp_eq_u32 s25, 7
    s_cbranch_scc1 K_L2e
    s_call_b64 s[54:55], K_LOADS2
K_L2e:
    s_nop 10
    v_pk_mul_f32 v[96:97], v[96:97], s[80:81]
    v_pk_mul_f32 v[112:113], v[112:113], s[80:81]
    v_cvt_pk_bf16_f32 v32, v96, v112
    ds_write_b32 v245, v32 offset:53632
    v_cvt_pk_bf16_f32 v33, v97, v113
    ds_write_b32 v245, v33 offset:53888
    v_pk_mul_f32 v[98:99], v[98:99], s[80:81]
    v_pk_mul_f32 v[114:115], v[114:115], s[80:81]
    v_cvt_pk_bf16_f32 v34, v98, v114
    ds_write_b32 v245, v34 offset:54144
    v_cvt_pk_bf16_f32 v35, v99, v115
    ds_write_b32 v245, v35 offset:54400
    v_pk_mul_f32 v[100:101], v[100:101], s[80:81]
    v_pk_mul_f32 v[116:117], v[116:117], s[80:81]
    v_cvt_pk_bf16_f32 v36, v100, v116
    ds_write_b32 v245, v36 offset:55680
    v_cvt_pk_bf16_f32 v37, v101, v117
    ds_write_b32 v245, v37 offset:55936
    v_pk_mul_f32 v[102:103], v[102:103], s[80:81]
    v_pk_mul_f32 v[118:119], v[118:119], s[80:81]
    v_cvt_pk_bf16_f32 v38, v102, v118
    ds_write_b32 v245, v38 offset:56192
    v_cvt_pk_bf16_f32 v39, v103, v119
    ds_write_b32 v245, v39 offset:56448
    s_cmp_lt_u32 s25, 4
    s_cbranch_scc1 K_BT8
    s_mov_b32 exec_hi, 0
    v_pk_mul_f32 v[104:105], v[104:105], s[80:81]
    v_pk_mul_f32 v[120:121], v[120:121], s[80:81]
    v_cvt_pk_bf16_f32 v40, v104, v120
    ds_write_b32 v245, v40 offset:57728
    s_mov_b32 exec_hi, -1
    s_branch K_NOBT
K_BT8:
    v_pk_mul_f32 v[104:105], v[104:105], s[80:81]
    v_pk_mul_f32 v[120:121], v[120:121], s[80:81]
    v_cvt_pk_bf16_f32 v40, v104, v120
    ds_write_b32 v245, v40 offset:57728
    v_cvt_pk_bf16_f32 v41, v105, v121
    ds_write_b32 v245, v41 offset:57984
    v_pk_mul_f32 v[106:107], v[106:107], s[80:81]
    v_pk_mul_f32 v[122:123], v[122:123], s[80:81]
    v_cvt_pk_bf16_f32 v42, v106, v122
    ds_write_b32 v245, v42 offset:58240
    v_cvt_pk_bf16_f32 v43, v107, v123
    ds_write_b32 v245, v43 offset:58496
    v_pk_mul_f32 v[108:109], v[108:109], s[80:81]
    v_pk_mul_f32 v[124:125], v[124:125], s[80:81]
    v_cvt_pk_bf16_f32 v44, v108, v124
    ds_write_b32 v245, v44 offset:59776
    v_cvt_pk_bf16_f32 v45, v109, v125
    ds_write_b32 v245, v45 offset:60032
    v_pk_mul_f32 v[110:111], v[110:111], s[80:81]
    v_pk_mul_f32 v[126:127], v[126:127], s[80:81]
    v_cvt_pk_bf16_f32 v46, v110, v126
    ds_write_b32 v245, v46 offset:60288
    v_cvt_pk_bf16_f32 v47, v111, v127
    ds_write_b32 v245, v47 offset:60544
K_NOBT:
    s_cmp_eq_u32 s25, 6
    s_cbranch_scc0 K_NOENT0
    s_waitcnt vmcnt(0)
    v_lshl_or_b32 v128, v156, 11, v164
    v_or_b32 v128, s43, v128
    v_mov_b32 v129, s42
    v_lshl_or_b32 v130, v157, 11, v165
    v_or_b32 v130, s43, v130
    v_mov_b32 v131, s42
    v_lshl_or_b32 v132, v158, 11, v166
    v_or_b32 v132, s43, v132
    v_mov_b32 v133, s42
    v_lshl_or_b32 v134, v159, 11, v167
    v_or_b32 v134, s43, v134
    v_mov_b32 v135, s42
    v_lshlrev_b32 v238, 5, v250
    s_lshl_b32 s3, s2, 11
    s_add_u32 s3, s3, 3211264
    buffer_store_dwordx4 v[128:131], v238, s[12:15], s3 offen sc1
    buffer_store_dwordx4 v[132:135], v238, s[12:15], s3 offen offset:16 sc1
K_NOENT0:
    s_waitcnt lgkmcnt(0)
    s_barrier
    s_cmp_eq_u32 s25, 7
    s_cbranch_scc0 K_NOB0
    s_lshl_b32 s82, s86, 8
    s_lshl_b32 s83, s87, 8
    s_add_u32 s44, s40, s82
    s_addc_u32 s45, s41, 0
    s_mov_b32 s46, s83
    s_mov_b32 s47, 0x20000
    ds_read_b128 v[128:131], v191 offset:0
    ds_read_b128 v[132:135], v191 offset:1024
    ds_read_b128 v[136:139], v191 offset:2048
    ds_read_b128 v[140:143], v191 offset:3072
    ds_read_b128 v[144:147], v191 offset:4096
    ds_read_b128 v[148:151], v191 offset:5120
    ds_read_b128 v[152:155], v191 offset:6144
    ds_read_b128 v[156:159], v191 offset:7168
    ds_read_b128 v[160:163], v191 offset:8192
    s_movk_i32 s3, 0
    s_waitcnt vmcnt(63) lgkmcnt(8)
    buffer_store_dwordx4 v[128:131], v190, s[44:47], s3 offen offset:0 sc1
    s_movk_i32 s3, 0
    s_waitcnt vmcnt(63) lgkmcnt(7)
    buffer_store_dwordx4 v[132:135], v190, s[44:47], s3 offen offset:1024 sc1
    s_movk_i32 s3, 0
    s_waitcnt vmcnt(63) lgkmcnt(6)
    buffer_store_dwordx4 v[136:139], v190, s[44:47], s3 offen offset:2048 sc1
    s_movk_i32 s3, 0
    s_waitcnt vmcnt(63) lgkmcnt(5)
    buffer_store_dwordx4 v[140:143], v190, s[44:47], s3 offen offset:3072 sc1
    s_movk_i32 s3, 4096
    s_waitcnt vmcnt(63) lgkmcnt(4)
    buffer_store_dwordx4 v[144:147], v190, s[44:47], s3 offen offset:0 sc1
    s_movk_i32 s3, 4096
    s_waitcnt vmcnt(63) lgkmcnt(3)
    buffer_store_dwordx4 v[148:151], v190, s[44:47], s3 offen offset:1024 sc1
    s_movk_i32 s3, 4096
    s_waitcnt vmcnt(63) lgkmcnt(2)
    buffer_store_dwordx4 v[152:155], v190, s[44:47], s3 offen offset:2048 sc1
    s_movk_i32 s3, 4096
    s_waitcnt vmcnt(63) lgkmcnt(1)
    buffer_store_dwordx4 v[156:159], v190, s[44:47], s3 offen offset:3072 sc1
    s_movk_i32 s3, 8192
    s_waitcnt vmcnt(63) lgkmcnt(0)
    buffer_store_dwordx4 v[160:163], v190, s[44:47], s3 offen offset:0 sc1
    ds_read_b128 v[128:131], v191 offset:9216
    ds_read_b128 v[132:135], v191 offset:10240
    ds_read_b128 v[136:139], v191 offset:11264
    s_movk_i32 s3, 8192
    s_waitcnt vmcnt(63) lgkmcnt(2)
    buffer_store_dwordx4 v[128:131], v190, s[44:47], s3 offen offset:1024 sc1
    s_movk_i32 s3, 8192
    s_waitcnt vmcnt(63) lgkmcnt(1)
    buffer_store_dwordx4 v[132:135], v190, s[44:47], s3 offen offset:2048 sc1
    s_movk_i32 s3, 8192
    s_waitcnt vmcnt(63) lgkmcnt(0)
    buffer_store_dwordx4 v[136:139], v190, s[44:47], s3 offen offset:3072 sc1
    s_waitcnt vmcnt(12)
    s_branch K_NOB1
K_NOB0:
K_NOB1:
    s_cmp_eq_u32 s25, 6
    s_cbranch_scc0 K_NOENT
    s_call_b64 s[54:55], K_LISTINIT
K_NOENT:
    v_lshrrev_b32 v138, 4, v254
    v_bfe_u32 v139, v250, 4, 2
    v_bfe_u32 v140, v250, 3, 1
    v_lshlrev_b32 v140, 1, v140
    v_xor_b32 v139, v139, v140
    v_lshlrev_b32 v138, 8, v138
    v_lshl_add_u32 v138, v139, 6, v138
    v_and_b32 v139, 7, v250
    v_lshl_add_u32 v138, v139, 3, v138
    v_xor_b32 v139, 64, v138
    v_add_u32 v138, 79232, v138
    v_add_u32 v139, 79232, v139
    s_mov_b32 s82, 0x05040100
    s_mov_b32 s83, 0x07060302
    s_cmp_eq_u32 s25, 7
    s_cbranch_scc1 K_W1
    s_waitcnt vmcnt(2)
    s_cmp_eq_u32 s25, 6
    s_cbranch_scc1 K_W1
    s_waitcnt vmcnt(0)
K_W1:
    v_mul_u32_u24 v199, 6, v254
    ds_read_u16 v192, v248 offset:42848
    ds_read_u16 v193, v248 offset:43104
    ds_read_u16 v194, v248 offset:42856
    ds_read_u16 v195, v248 offset:43112
    ds_read_u16 v212, v249 offset:43360
    ds_read_u16 v213, v249 offset:43368
    ds_read_u16 v214, v249 offset:43376
    ds_read_u16 v215, v249 offset:43384
    ds_read_u16 v196, v199 offset:43616
    ds_read_u16 v197, v199 offset:43618
    ds_read_u16 v198, v199 offset:43620
    v_perm_b32 v146, v171, v170, s82
    v_perm_b32 v147, v173, v172, s82
    v_perm_b32 v148, v171, v170, s83
    v_perm_b32 v149, v173, v172, s83
    ds_write_b64 v138, v[146:147] offset:0
    ds_write_b64 v139, v[148:149] offset:0
    v_perm_b32 v150, v175, v174, s82
    v_perm_b32 v151, v177, v176, s82
    v_perm_b32 v152, v175, v174, s83
    v_perm_b32 v153, v177, v176, s83
    ds_write_b64 v138, v[150:151] offset:8192
    ds_write_b64 v139, v[152:153] offset:8192
    v_perm_b32 v146, v179, v178, s82
    v_perm_b32 v147, v181, v180, s82
    v_perm_b32 v148, v179, v178, s83
    v_perm_b32 v149, v181, v180, s83
    ds_write_b64 v138, v[146:147] offset:16384
    ds_write_b64 v139, v[148:149] offset:16384
    v_perm_b32 v150, v183, v182, s82
    v_perm_b32 v151, v185, v184, s82
    v_perm_b32 v152, v183, v182, s83
    v_perm_b32 v153, v185, v184, s83
    ds_write_b64 v138, v[150:151] offset:24576
    ds_write_b64 v139, v[152:153] offset:24576
    s_waitcnt lgkmcnt(8)
    s_mov_b32 s3, 0xbf317218
    v_lshlrev_b32 v192, 16, v192
    v_lshlrev_b32 v212, 16, v212
    v_lshlrev_b32 v193, 16, v193
    v_lshlrev_b32 v213, 16, v213
    v_lshlrev_b32 v194, 16, v194
    v_lshlrev_b32 v214, 16, v214
    v_lshlrev_b32 v195, 16, v195
    v_lshlrev_b32 v215, 16, v215
    v_mul_f32 v192, s80, v192
    v_mul_f32 v212, s3, v212
    v_mul_f32 v193, s80, v193
    v_mul_f32 v213, s3, v213
    v_mul_f32 v194, s80, v194
    v_mul_f32 v214, s3, v214
    v_mul_f32 v195, s80, v195
    v_mul_f32 v215, s3, v215
    v_cvt_pk_bf16_f32 v208, v192, v193
    v_cvt_pk_bf16_f32 v210, v194, v195
    v_lshlrev_b32 v216, 4, v254
    v_lshlrev_b32 v209, 16, v208
    v_and_b32 v211, 0xffff0000, v208
    v_sub_f32 v192, v192, v209
    v_sub_f32 v193, v193, v211
    v_lshlrev_b32 v209, 16, v210
    v_and_b32 v211, 0xffff0000, v210
    v_sub_f32 v194, v194, v209
    v_sub_f32 v195, v195, v211
    v_cvt_pk_bf16_f32 v209, v192, v193
    v_cvt_pk_bf16_f32 v211, v194, v195
    v_cmp_gt_u32 vcc, 98, v254
    v_lshlrev_b32 v192, 16, v196
    v_lshlrev_b32 v193, 16, v197
    v_lshlrev_b32 v194, 16, v198
    v_mov_b32 v195, 0
    s_mov_b64 exec, vcc
    ds_write_b128 v216, v[192:195] offset:320
    s_mov_b64 exec, -1
    s_waitcnt lgkmcnt(0)
    s_barrier
    s_mov_b32 s4, s40
    s_or_b32 s5, s41, 0x1000000
    s_mov_b32 s6, 25000
    s_mov_b32 s7, 0x20000
    s_lshl_b32 s82, s86, 8
    s_lshl_b32 s83, s87, 8
    s_add_u32 s20, s36, s82
    s_addc_u32 s21, s37, 0
    s_mov_b32 s22, s83
    s_mov_b32 s23, 0x20000
K_ROUND:
    v_mov_b32 v184, 1
    v_mov_b32 v185, 0
    v_lshlrev_b32 v186, 2, v250
    s_cmp_lt_u32 s25, 4
    s_cbranch_scc1 K_FETCH
    s_cmp_eq_u32 s26, 0
    s_cbranch_scc0 K_B1
    s_cmp_eq_u32 s25, 7
    s_cbranch_scc1 K_PUBAC
    s_call_b64 s[54:55], K_A
    s_call_b64 s[54:55], K_C
    s_branch K_B1
K_PUBAC:
    ds_read_b128 v[128:131], v191 offset:12288
    ds_read_b128 v[132:135], v191 offset:13312
    ds_read_b128 v[136:139], v191 offset:14336
    ds_read_b128 v[140:143], v191 offset:15360
    ds_read_b128 v[144:147], v191 offset:16384
    ds_read_b128 v[148:151], v191 offset:17408
    ds_read_b128 v[152:155], v191 offset:18432
    ds_read_b128 v[156:159], v191 offset:19456
    ds_read_b128 v[160:163], v191 offset:20480
    s_movk_i32 s3, 12288
    s_waitcnt vmcnt(63) lgkmcnt(8)
    buffer_store_dwordx4 v[128:131], v190, s[44:47], s3 offen offset:0 sc1
    s_movk_i32 s3, 12288
    s_waitcnt vmcnt(63) lgkmcnt(7)
    buffer_store_dwordx4 v[132:135], v190, s[44:47], s3 offen offset:1024 sc1
    s_movk_i32 s3, 12288
    s_waitcnt vmcnt(63) lgkmcnt(6)
    buffer_store_dwordx4 v[136:139], v190, s[44:47], s3 offen offset:2048 sc1
    s_movk_i32 s3, 12288
    s_waitcnt vmcnt(63) lgkmcnt(5)
    buffer_store_dwordx4 v[140:143], v190, s[44:47], s3 offen offset:3072 sc1
    s_movk_i32 s3, 16384
    s_waitcnt vmcnt(15) lgkmcnt(4)
    buffer_store_dwordx4 v[144:147], v190, s[44:47], s3 offen offset:0 sc1
    s_movk_i32 s3, 16384
    s_waitcnt vmcnt(15) lgkmcnt(3)
    buffer_store_dwordx4 v[148:151], v190, s[44:47], s3 offen offset:1024 sc1
    s_movk_i32 s3, 16384
    s_waitcnt vmcnt(15) lgkmcnt(2)
    buffer_store_dwordx4 v[152:155], v190, s[44:47], s3 offen offset:2048 sc1
    s_movk_i32 s3, 16384
    s_waitcnt vmcnt(15) lgkmcnt(1)
    buffer_store_dwordx4 v[156:159], v190, s[44:47], s3 offen offset:3072 sc1
    s_movk_i32 s3, 20480
    s_waitcnt vmcnt(15) lgkmcnt(0)
    buffer_store_dwordx4 v[160:163], v190, s[44:47], s3 offen offset:0 sc1
    ds_read_b128 v[128:131], v191 offset:21504
    ds_read_b128 v[132:135], v191 offset:22528
    ds_read_b128 v[136:139], v191 offset:23552
    ds_read_b128 v[140:143], v191 offset:24576
    s_movk_i32 s3, 20480
    s_waitcnt vmcnt(15) lgkmcnt(3)
    buffer_store_dwordx4 v[128:131], v190, s[44:47], s3 offen offset:1024 sc1
    s_movk_i32 s3, 20480
    s_waitcnt vmcnt(15) lgkmcnt(2)
    buffer_store_dwordx4 v[132:135], v190, s[44:47], s3 offen offset:2048 sc1
    s_movk_i32 s3, 20480
    s_waitcnt vmcnt(15) lgkmcnt(1)
    buffer_store_dwordx4 v[136:139], v190, s[44:47], s3 offen offset:3072 sc1
    s_movk_i32 s3, 24576
    s_waitcnt vmcnt(15) lgkmcnt(0)
    buffer_store_dwordx4 v[140:143], v190, s[44:47], s3 offen offset:0 sc1
    s_call_b64 s[54:55], K_A
    s_call_b64 s[54:55], K_C
    v_lshlrev_b32 v128, 14, v250
    s_lshl_b32 s3, s2, 6
    s_add_u32 s3, s3, 3735552
    v_mov_b32 v130, s43
    v_mov_b32 v131, s42
    s_waitcnt vmcnt(0)
    s_mov_b64 exec, 0xff
    buffer_store_dwordx2 v[130:131], v128, s[12:15], s3 offen sc1
    s_mov_b64 exec, -1
    s_branch K_B1
K_FETCH:
    v_lshrrev_b32 v187, 2, v254
    v_lshlrev_b32 v188, 11, v187
    s_lshl_b32 s82, s24, 3
    s_add_u32 s82, s82, 3211264
    s_add_u32 s83, s82, 131072
    s_add_u32 s84, s82, 262144
    s_add_u32 s85, s82, 393216
    s_xor_b32 s53, s26, 1
K_POLL:
    buffer_load_dwordx2 v[192:193], v188, s[12:15], s82 offen sc1
    buffer_load_dwordx2 v[194:195], v188, s[12:15], s83 offen sc1
    buffer_load_dwordx2 v[196:197], v188, s[12:15], s84 offen sc1
    buffer_load_dwordx2 v[198:199], v188, s[12:15], s85 offen sc1
    v_and_b32 v189, 3, v250
    v_lshlrev_b32 v190, 2, v189
    v_lshl_add_u32 v189, v189, 1, s29
    v_mul_u32_u24 v191, 12544, v187
    v_lshl_add_u32 v191, v189, 3, v191
    s_add_u32 s95, s95, 1
    s_cmp_eq_u32 s53, 0
    s_cbranch_scc1 K_NOA
    s_mov_b32 s53, 0
    s_call_b64 s[54:55], K_A
K_NOA:
    s_waitcnt vmcnt(0)
    v_xor_b32 v176, s43, v192
    v_xor_b32 v180, s42, v193
    v_xor_b32 v177, s43, v194
    v_xor_b32 v181, s42, v195
    v_xor_b32 v178, s43, v196
    v_xor_b32 v182, s42, v197
    v_xor_b32 v179, s43, v198
    v_xor_b32 v183, s42, v199
    v_or3_b32 v238, v176, v177, v178
    v_or3_b32 v239, v180, v181, v182
    v_or_b32 v238, v238, v179
    v_lshrrev_b32 v238, 22, v238
    v_or3_b32 v238, v238, v239, v183
    v_cmp_ne_u32 vcc, 0, v238
    s_cmp_gt_u32 s95, 200000
    s_cbranch_scc1 K_POLLOK
    s_cmp_eq_u64 vcc, 0
    s_cbranch_scc1 K_POLLOK
    s_mov_b64 exec, vcc
    s_branch K_POLL
K_POLLOK:
    s_mov_b64 exec, -1
    v_and_b32 v180, 0x7ff, v192
    v_bfe_u32 v192, v192, 11, 11
    v_lshl_add_u32 v180, v180, 3, v191
    v_sub_u32 v176, v192, v189
    v_and_b32 v181, 0x7ff, v194
    v_bfe_u32 v194, v194, 11, 11
    v_lshl_add_u32 v181, v181, 3, v191
    v_sub_u32 v177, v194, v189
    v_and_b32 v182, 0x7ff, v196
    v_bfe_u32 v196, v196, 11, 11
    v_lshl_add_u32 v182, v182, 3, v191
    v_sub_u32 v178, v196, v189
    v_and_b32 v183, 0x7ff, v198
    v_bfe_u32 v198, v198, 11, 11
    v_lshl_add_u32 v183, v183, 3, v191
    v_sub_u32 v179, v198, v189
    s_cmp_eq_u32 s27, 0
    s_cbranch_scc1 K_ALLQ
    s_cmp_eq_u32 s28, 0
    s_cselect_b32 s3, -1, 0
    v_and_b32 v176, s3, v176
    s_cmp_eq_u32 s28, 1
    s_cselect_b32 s3, -1, 0
    v_and_b32 v177, s3, v177
    s_cmp_eq_u32 s28, 2
    s_cselect_b32 s3, -1, 0
    v_and_b32 v178, s3, v178
    s_cmp_eq_u32 s28, 3
    s_cselect_b32 s3, -1, 0
    v_and_b32 v179, s3, v179
K_ALLQ:
    s_mov_b32 s83, 802816
    s_mov_b32 s84, 1605632
    s_mov_b32 s85, 2408448
    v_cmpx_lt_i32 vcc, 0, v176
    buffer_load_dwordx4 v[128:131], v180, s[12:15], 0 offen offset:0 sc1
    v_cmpx_lt_i32 vcc, 8, v176
    buffer_load_dwordx4 v[144:147], v180, s[12:15], 0 offen offset:64 sc1
    s_mov_b64 exec, -1
    v_cmpx_lt_i32 vcc, 0, v177
    buffer_load_dwordx4 v[132:135], v181, s[12:15], s83 offen offset:0 sc1
    v_cmpx_lt_i32 vcc, 8, v177
    buffer_load_dwordx4 v[148:151], v181, s[12:15], s83 offen offset:64 sc1
    s_mov_b64 exec, -1
    v_cmpx_lt_i32 vcc, 0, v178
    buffer_load_dwordx4 v[136:139], v182, s[12:15], s84 offen offset:0 sc1
    v_cmpx_lt_i32 vcc, 8, v178
    buffer_load_dwordx4 v[152:155], v182, s[12:15], s84 offen offset:64 sc1
    s_mov_b64 exec, -1
    v_cmpx_lt_i32 vcc, 0, v179
    buffer_load_dwordx4 v[140:143], v183, s[12:15], s85 offen offset:0 sc1
    v_cmpx_lt_i32 vcc, 8, v179
    buffer_load_dwordx4 v[156:159], v183, s[12:15], s85 offen offset:64 sc1
    s_mov_b64 exec, -1
    v_max3_i32 v238, v176, v177, v178
    v_max3_u32 v239, v192, v194, v196
    v_max_i32 v238, v238, v179
    v_max_u32 v239, v239, v198
    v_cmp_lt_i32 s[60:61], 16, v238
    s_add_u32 s3, s29, 24
    v_cmp_lt_u32 vcc, s3, v239
    s_cmp_eq_u64 s[60:61], 0
    s_cselect_b32 s52, 0, 1
    s_mov_b64 exec, vcc
    ds_write_b32 v185, v184 offset:256
    s_mov_b64 exec, -1
    s_cbranch_scc1 K_NOT2
    v_cmpx_lt_i32 vcc, 16, v176
    buffer_load_dwordx4 v[160:163], v180, s[12:15], 0 offen offset:128 sc1
    s_mov_b64 exec, -1
    v_cmpx_lt_i32 vcc, 16, v177
    buffer_load_dwordx4 v[164:167], v181, s[12:15], s83 offen offset:128 sc1
    s_mov_b64 exec, -1
    v_cmpx_lt_i32 vcc, 16, v178
    buffer_load_dwordx4 v[168:171], v182, s[12:15], s84 offen offset:128 sc1
    s_mov_b64 exec, -1
    v_cmpx_lt_i32 vcc, 16, v179
    buffer_load_dwordx4 v[172:175], v183, s[12:15], s85 offen offset:128 sc1
    s_mov_b64 exec, -1
K_NOT2:
    s_cmp_eq_u32 s26, 0
    s_cbranch_scc0 K_RANK
    s_call_b64 s[54:55], K_C
K_RANK:
    s_movk_i32 s3, 0xf0
    s_waitcnt vmcnt(0)
    v_cmpx_lt_i32 vcc, 0, v176
    v_and_or_b32 v0, v129, s3, v190
    ds_add_rtn_u32 v24, v0, v184 offset:0
    v_cmpx_lt_i32 vcc, 1, v176
    v_and_or_b32 v1, v131, s3, v190
    ds_add_rtn_u32 v25, v1, v184 offset:0
    v_cmpx_lt_i32 vcc, 8, v176
    v_and_or_b32 v8, v145, s3, v190
    ds_add_rtn_u32 v32, v8, v184 offset:0
    v_cmpx_lt_i32 vcc, 9, v176
    v_and_or_b32 v9, v147, s3, v190
    ds_add_rtn_u32 v33, v9, v184 offset:0
    s_mov_b64 exec, -1
    v_cmpx_lt_i32 vcc, 0, v177
    v_and_or_b32 v2, v133, s3, v190
    ds_add_rtn_u32 v26, v2, v184 offset:0
    v_cmpx_lt_i32 vcc, 1, v177
    v_and_or_b32 v3, v135, s3, v190
    ds_add_rtn_u32 v27, v3, v184 offset:0
    v_cmpx_lt_i32 vcc, 8, v177
    v_and_or_b32 v10, v149, s3, v190
    ds_add_rtn_u32 v34, v10, v184 offset:0
    v_cmpx_lt_i32 vcc, 9, v177
    v_and_or_b32 v11, v151, s3, v190
    ds_add_rtn_u32 v35, v11, v184 offset:0
    s_mov_b64 exec, -1
    v_cmpx_lt_i32 vcc, 0, v178
    v_and_or_b32 v4, v137, s3, v190
    ds_add_rtn_u32 v28, v4, v184 offset:0
    v_cmpx_lt_i32 vcc, 1, v178
    v_and_or_b32 v5, v139, s3, v190
    ds_add_rtn_u32 v29, v5, v184 offset:0
    v_cmpx_lt_i32 vcc, 8, v178
    v_and_or_b32 v12, v153, s3, v190
    ds_add_rtn_u32 v36, v12, v184 offset:0
    v_cmpx_lt_i32 vcc, 9, v178
    v_and_or_b32 v13, v155, s3, v190
    ds_add_rtn_u32 v37, v13, v184 offset:0
    s_mov_b64 exec, -1
    v_cmpx_lt_i32 vcc, 0, v179
    v_and_or_b32 v6, v141, s3, v190
    ds_add_rtn_u32 v30, v6, v184 offset:0
    v_cmpx_lt_i32 vcc, 1, v179
    v_and_or_b32 v7, v143, s3, v190
    ds_add_rtn_u32 v31, v7, v184 offset:0
    v_cmpx_lt_i32 vcc, 8, v179
    v_and_or_b32 v14, v157, s3, v190
    ds_add_rtn_u32 v38, v14, v184 offset:0
    v_cmpx_lt_i32 vcc, 9, v179
    v_and_or_b32 v15, v159, s3, v190
    ds_add_rtn_u32 v39, v15, v184 offset:0
    s_mov_b64 exec, -1
    s_cmp_eq_u32 s52, 0
    s_cbranch_scc1 K_B1
    v_cmpx_lt_i32 vcc, 16, v176
    v_and_or_b32 v16, v161, s3, v190
    ds_add_rtn_u32 v40, v16, v184 offset:0
    v_cmpx_lt_i32 vcc, 17, v176
    v_and_or_b32 v17, v163, s3, v190
    ds_add_rtn_u32 v41, v17, v184 offset:0
    s_mov_b64 exec, -1
    v_cmpx_lt_i32 vcc, 16, v177
    v_and_or_b32 v18, v165, s3, v190
    ds_add_rtn_u32 v42, v18, v184 offset:0
    v_cmpx_lt_i32 vcc, 17, v177
    v_and_or_b32 v19, v167, s3, v190
    ds_add_rtn_u32 v43, v19, v184 offset:0
    s_mov_b64 exec, -1
    v_cmpx_lt_i32 vcc, 16, v178
    v_and_or_b32 v20, v169, s3, v190
    ds_add_rtn_u32 v44, v20, v184 offset:0
    v_cmpx_lt_i32 vcc, 17, v178
    v_and_or_b32 v21, v171, s3, v190
    ds_add_rtn_u32 v45, v21, v184 offset:0
    s_mov_b64 exec, -1
    v_cmpx_lt_i32 vcc, 16, v179
    v_and_or_b32 v22, v173, s3, v190
    ds_add_rtn_u32 v46, v22, v184 offset:0
    v_cmpx_lt_i32 vcc, 17, v179
    v_and_or_b32 v23, v175, s3, v190
    ds_add_rtn_u32 v47, v23, v184 offset:0
    s_mov_b64 exec, -1
K_B1:
    s_waitcnt lgkmcnt(0)
    s_barrier
    ds_read_b32 v48, v186 offset:0
    ds_read_b32 v53, v185 offset:256
    v_mov_b64 v[192:193], 0
    v_mov_b64 v[194:195], 0
    s_lshl_b32 s3, s25, 12
    s_add_u32 s3, s3, 129408
    v_lshl_add_u32 v49, v250, 4, s3
    ds_write_b128 v49, v[192:195] offset:0
    ds_write_b128 v49, v[192:195] offset:1024
    ds_write_b128 v49, v[192:195] offset:2048
    ds_write_b128 v49, v[192:195] offset:3072
    s_waitcnt lgkmcnt(4)
    s_mov_b32 s82, 0xaaaaaaaa
    s_mov_b32 s83, 0xaaaaaaaa
    s_mov_b32 s84, 0xcccccccc
    s_mov_b32 s85, 0xcccccccc
    v_mov_b32_dpp v49, v48 quad_perm:[1,0,3,2] row_mask:0xf bank_mask:0xf
    v_add_u32 v50, v48, v49
    v_readfirstlane_b32 s30, v53
    s_nop 0
    v_mov_b32_dpp v51, v50 quad_perm:[2,3,0,1] row_mask:0xf bank_mask:0xf
    v_add3_u32 v52, v50, v51, 7
    v_lshrrev_b32 v52, 3, v52
    v_mov_b32 v233, v52
    v_cndmask_b32_e64 v49, 0, v49, s[82:83]
    v_cndmask_b32_e64 v51, 0, v51, s[84:85]
    v_add_u32_dpp v233, v233, v233 row_shr:4 row_mask:0xf bank_mask:0xf
    v_add_u32 v49, v49, v51
    v_cmp_eq_u32 s[84:85], 0, v52
    v_add_u32_dpp v233, v233, v233 row_shr:8 row_mask:0xf bank_mask:0xf
    v_lshlrev_b32 v49, 3, v49
    v_add_u32 v49, 112000, v49
    v_add_u32_dpp v233, v233, v233 row_bcast:15 row_mask:0xa bank_mask:0xf
    s_mov_b32 s49, s26
    s_mov_b32 s50, 0
    v_add_u32_dpp v233, v233, v233 row_bcast:31 row_mask:0xc bank_mask:0xf
    s_and_b64 s[84:85], s[84:85], s[62:63]
    s_cselect_b32 s53, 1, 0
    v_sub_u32 v53, v233, v52
    v_readlane_b32 s35, v233, 63
    v_lshl_add_u32 v53, v53, 6, v49
    s_add_u32 s35, s35, 1
    s_lshr_b32 s35, s35, 1
    s_cmp_gt_u32 s35, 128
    s_cselect_b32 s94, 1, 0
    s_cselect_b32 s35, 0, s35
    s_cmp_lt_u32 s25, 4
    s_cbranch_scc1 K_PLACE
    s_cmp_eq_u32 s26, 0
    s_cbranch_scc0 K_NOPLACE
    v_and_b32 v128, 255, v254
    v_lshlrev_b32 v128, 6, v128
    s_and_b32 s3, s2, 7
    s_lshl_b32 s3, s3, 14
    s_add_u32 s3, s3, 3735552
K_POLL2:
    buffer_load_dwordx2 v[130:131], v128, s[12:15], s3 offen sc1
    s_add_u32 s95, s95, 1
    s_waitcnt vmcnt(0)
    v_cmp_ne_u32 vcc, s43, v130
    v_cmp_ne_u32 s[82:83], s42, v131
    s_cmp_gt_u32 s95, 200000
    s_cbranch_scc1 K_NOPLACE
    s_or_b64 vcc, vcc, s[82:83]
    s_cbranch_scc0 K_NOPLACE
    s_mov_b64 exec, vcc
    s_branch K_POLL2
K_PLACE:
    s_cmp_lg_u32 s94, 0
    s_cbranch_scc1 K_NOPLACE
    ds_bpermute_b32 v0, v0, v53
    ds_bpermute_b32 v1, v1, v53
    ds_bpermute_b32 v2, v2, v53
    ds_bpermute_b32 v3, v3, v53
    ds_bpermute_b32 v4, v4, v53
    ds_bpermute_b32 v5, v5, v53
    ds_bpermute_b32 v6, v6, v53
    ds_bpermute_b32 v7, v7, v53
    s_waitcnt lgkmcnt(7)
    ds_bpermute_b32 v8, v8, v53
    ds_bpermute_b32 v9, v9, v53
    ds_bpermute_b32 v10, v10, v53
    ds_bpermute_b32 v11, v11, v53
    ds_bpermute_b32 v12, v12, v53
    ds_bpermute_b32 v13, v13, v53
    ds_bpermute_b32 v14, v14, v53
    ds_bpermute_b32 v15, v15, v53
    s_waitcnt lgkmcnt(0)
    v_cmpx_lt_i32 vcc, 0, v176
    v_lshl_add_u32 v0, v24, 3, v0
    ds_write_b64 v0, v[128:129]
    v_cmpx_lt_i32 vcc, 1, v176
    v_lshl_add_u32 v1, v25, 3, v1
    ds_write_b64 v1, v[130:131]
    v_cmpx_lt_i32 vcc, 8, v176
    v_lshl_add_u32 v8, v32, 3, v8
    ds_write_b64 v8, v[144:145]
    v_cmpx_lt_i32 vcc, 9, v176
    v_lshl_add_u32 v9, v33, 3, v9
    ds_write_b64 v9, v[146:147]
    s_mov_b64 exec, -1
    v_cmpx_lt_i32 vcc, 0, v177
    v_lshl_add_u32 v2, v26, 3, v2
    ds_write_b64 v2, v[132:133]
    v_cmpx_lt_i32 vcc, 1, v177
    v_lshl_add_u32 v3, v27, 3, v3
    ds_write_b64 v3, v[134:135]
    v_cmpx_lt_i32 vcc, 8, v177
    v_lshl_add_u32 v10, v34, 3, v10
    ds_write_b64 v10, v[148:149]
    v_cmpx_lt_i32 vcc, 9, v177
    v_lshl_add_u32 v11, v35, 3, v11
    ds_write_b64 v11, v[150:151]
    s_mov_b64 exec, -1
    v_cmpx_lt_i32 vcc, 0, v178
    v_lshl_add_u32 v4, v28, 3, v4
    ds_write_b64 v4, v[136:137]
    v_cmpx_lt_i32 vcc, 1, v178
    v_lshl_add_u32 v5, v29, 3, v5
    ds_write_b64 v5, v[138:139]
    v_cmpx_lt_i32 vcc, 8, v178
    v_lshl_add_u32 v12, v36, 3, v12
    ds_write_b64 v12, v[152:153]
    v_cmpx_lt_i32 vcc, 9, v178
    v_lshl_add_u32 v13, v37, 3, v13
    ds_write_b64 v13, v[154:155]
    s_mov_b64 exec, -1
    v_cmpx_lt_i32 vcc, 0, v179
    v_lshl_add_u32 v6, v30, 3, v6
    ds_write_b64 v6, v[140:141]
    v_cmpx_lt_i32 vcc, 1, v179
    v_lshl_add_u32 v7, v31, 3, v7
    ds_write_b64 v7, v[142:143]
    v_cmpx_lt_i32 vcc, 8, v179
    v_lshl_add_u32 v14, v38, 3, v14
    ds_write_b64 v14, v[156:157]
    v_cmpx_lt_i32 vcc, 9, v179
    v_lshl_add_u32 v15, v39, 3, v15
    ds_write_b64 v15, v[158:159]
    s_mov_b64 exec, -1
    s_cmp_eq_u32 s52, 0
    s_cbranch_scc1 K_NOPLACE
    s_waitcnt lgkmcnt(0)
    ds_bpermute_b32 v16, v16, v53
    ds_bpermute_b32 v17, v17, v53
    ds_bpermute_b32 v18, v18, v53
    ds_bpermute_b32 v19, v19, v53
    ds_bpermute_b32 v20, v20, v53
    ds_bpermute_b32 v21, v21, v53
    ds_bpermute_b32 v22, v22, v53
    ds_bpermute_b32 v23, v23, v53
    s_waitcnt lgkmcnt(0)
    v_cmpx_lt_i32 vcc, 16, v176
    v_lshl_add_u32 v16, v40, 3, v16
    ds_write_b64 v16, v[160:161]
    v_cmpx_lt_i32 vcc, 17, v176
    v_lshl_add_u32 v17, v41, 3, v17
    ds_write_b64 v17, v[162:163]
    s_mov_b64 exec, -1
    v_cmpx_lt_i32 vcc, 16, v177
    v_lshl_add_u32 v18, v42, 3, v18
    ds_write_b64 v18, v[164:165]
    v_cmpx_lt_i32 vcc, 17, v177
    v_lshl_add_u32 v19, v43, 3, v19
    ds_write_b64 v19, v[166:167]
    s_mov_b64 exec, -1
    v_cmpx_lt_i32 vcc, 16, v178
    v_lshl_add_u32 v20, v44, 3, v20
    ds_write_b64 v20, v[168:169]
    v_cmpx_lt_i32 vcc, 17, v178
    v_lshl_add_u32 v21, v45, 3, v21
    ds_write_b64 v21, v[170:171]
    s_mov_b64 exec, -1
    v_cmpx_lt_i32 vcc, 16, v179
    v_lshl_add_u32 v22, v46, 3, v22
    ds_write_b64 v22, v[172:173]
    v_cmpx_lt_i32 vcc, 17, v179
    v_lshl_add_u32 v23, v47, 3, v23
    ds_write_b64 v23, v[174:175]
    s_mov_b64 exec, -1
K_NOPLACE:
    s_mov_b64 exec, -1
    s_lshr_b32 s82, s35, 3
    s_lshl_b32 s3, s82, 1
    v_cmp_lt_u32 vcc, s3, v52
    s_and_b32 s83, s35, 7
    s_mul_i32 s31, s82, s25
    s_min_u32 s84, s25, s83
    s_add_u32 s31, s31, s84
    s_cmp_lt_u32 s25, s83
    s_addc_u32 s32, s31, s82
    s_or_b32 s51, vcc_lo, vcc_hi
    s_or_b32 s53, s53, s94
    s_lshl_b32 s3, s31, 7
    s_lshl_b32 s31, s31, 1
    s_lshl_b32 s32, s32, 1
    s_mov_b32 s96, 0
    s_add_u32 s3, s3, 112000
    v_bfe_u32 v224, v250, 2, 1
    v_bfe_u32 v251, v250, 3, 2
    v_lshl_add_u32 v251, v224, 2, v251
    v_lshl_add_u32 v224, v251, 3, s3
    v_lshl_add_u32 v229, v250, 3, s3
    v_cmp_ge_u32 vcc, s31, v233
    v_mov_b64 v[248:249], 0
    v_mov_b64 v[196:197], 0
    v_mov_b64 v[198:199], 0
    s_and_b64 vcc, vcc, s[62:63]
    s_bcnt1_i32_b64 s33, vcc
    s_lshl_b32 s3, s33, 2
    v_readlane_b32 s34, v233, s3
    v_mov_b32 v245, v228
    s_cmp_eq_u32 s26, 0
    s_cbranch_scc0 K_B2
    v_pk_mul_f32 v[64:65], v[64:65], s[80:81]
    v_pk_mul_f32 v[66:67], v[66:67], s[80:81]
    v_pk_mul_f32 v[68:69], v[68:69], s[80:81]
    v_pk_mul_f32 v[70:71], v[70:71], s[80:81]
    v_pk_mul_f32 v[72:73], v[72:73], s[80:81]
    v_pk_mul_f32 v[74:75], v[74:75], s[80:81]
    v_pk_mul_f32 v[76:77], v[76:77], s[80:81]
    v_pk_mul_f32 v[78:79], v[78:79], s[80:81]
    v_pk_mul_f32 v[80:81], v[80:81], s[80:81]
    v_pk_mul_f32 v[82:83], v[82:83], s[80:81]
    v_pk_mul_f32 v[84:85], v[84:85], s[80:81]
    v_pk_mul_f32 v[86:87], v[86:87], s[80:81]
    v_pk_mul_f32 v[88:89], v[88:89], s[80:81]
    v_pk_mul_f32 v[90:91], v[90:91], s[80:81]
    v_pk_mul_f32 v[92:93], v[92:93], s[80:81]
    v_pk_mul_f32 v[94:95], v[94:95], s[80:81]
K_B2:
    s_add_u32 s44, s78, 32768
    s_addc_u32 s45, s79, 0
    s_mov_b32 s46, 32768
    s_mov_b32 s47, 0x20000
    s_waitcnt lgkmcnt(0)
    s_barrier
    s_cmp_eq_u32 s26, 0
    s_cbranch_scc0 K_NOPUB
    s_cmp_eq_u32 s53, 0
    s_cbranch_scc1 K_NOPUB
    s_call_b64 s[54:55], K_ZERO
K_NOPUB:
    s_cmp_lg_u32 s94, 0
    s_cbranch_scc1 K2_OVER
    s_cmp_lt_u32 s31, s32
    s_cbranch_scc0 K2_WAVE_DONE
    ds_read_b64 v[234:235], v229
    ds_read_u16 v144, v224
    ds_read_u16 v146, v224 offset:64
    ds_read_u16 v148, v224 offset:128
    ds_read_u16 v150, v224 offset:192
    ds_read_u16 v216, v224 offset:256
    v_mov_b32 v145, v217
    v_mov_b32 v147, v217
    v_mov_b32 v149, v217
    v_mov_b32 v151, v217
    s_mov_b32 s6, 25000
    s_waitcnt lgkmcnt(5)
    v_and_b32 v128, 0xffff, v234
    v_bfe_u32 v129, v234, 16, 7
    v_mul_u32_u24 v128, 6, v128
    v_lshlrev_b32 v129, 4, v129
    v_and_b32 v128, -4, v128
    buffer_load_dwordx2 v[236:237], v128, s[8:11], 0 offen
    ds_read_b128 v[238:241], v129 offset:320
    s_waitcnt lgkmcnt(1)
    buffer_load_dwordx4 v[160:163], v[144:145], s[4:7], 0 idxen offen sc1
    buffer_load_dwordx4 v[164:167], v[144:145], s[4:7], 0 idxen offen offset:128 sc1
    v_bfe_u32 v130, v234, 16, 7
    v_mul_u32_u24 v130, 528, v130
    ds_write_b32 v230, v130 offset:256
    ds_read_b128 v[218:221], v226
    v_mfma_f32_32x32x16_bf16 v[0:15], v[192:195], v[192:195], 0
    v_mfma_f32_32x32x16_bf16 v[16:31], v[192:195], v[192:195], 0
    v_mfma_f32_32x32x16_bf16 v[32:47], v[192:195], v[192:195], 0
    v_mfma_f32_32x32x16_bf16 v[48:63], v[192:195], v[192:195], 0
    buffer_load_dwordx4 v[168:171], v[146:147], s[4:7], 0 idxen offen sc1
    buffer_load_dwordx4 v[172:175], v[146:147], s[4:7], 0 idxen offen offset:128 sc1
    s_add_u32 s3, s31, 2
    s_cmp_lt_u32 s3, s32
    s_cselect_b32 s6, 25000, 0
    s_waitcnt lgkmcnt(0)
    v_lshl_add_u64 v[218:219], v[218:219], 0, v[222:223]
    v_lshl_add_u64 v[220:221], v[220:221], 0, v[222:223]
    ds_read_b128 v[96:99], v218
    ds_read_b128 v[100:103], v219
    ds_read_b128 v[104:107], v220
    ds_read_b128 v[108:111], v221
    ds_read_b128 v[218:221], v226 offset:32
    s_waitcnt vmcnt(4)
    buffer_load_dwordx4 v[176:179], v[148:149], s[4:7], 0 idxen offen sc1
    buffer_load_dwordx4 v[180:183], v[148:149], s[4:7], 0 idxen offen offset:128 sc1
    v_lshlrev_b32 v128, 4, v234
    v_cmp_lt_i32 s[60:61], -1, v234
    v_alignbit_b32 v129, v237, v236, v128
    v_lshrrev_b32 v130, v128, v237
    v_lshlrev_b32 v131, 16, v129
    v_and_b32 v132, 0xffff0000, v129
    v_lshlrev_b32 v133, 16, v130
    v_sub_f32 v131, v238, v131
    v_sub_f32 v132, v239, v132
    v_sub_f32 v133, v240, v133
    v_cvt_pk_bf16_f32 v242, 1.0, v131
    v_cvt_pk_bf16_f32 v243, v132, v133
    v_bfe_u32 v134, v234, 16, 7
    v_bfe_u32 v135, v234, 16, 3
    v_and_b32 v131, 0xffff0000, v242
    v_lshlrev_b32 v132, 16, v243
    v_and_b32 v133, 0xffff0000, v243
    v_mul_f32 v131, v131, v131
    v_mul_f32 v132, v132, v132
    v_mul_f32 v133, v133, v133
    v_mul_u32_u24 v241, 528, v134
    v_lshl_add_u32 v244, v135, 3, v228
    v_cvt_pk_bf16_f32 v131, v131, v132
    v_cvt_pk_bf16_f32 v133, 0, v133
    v_lshlrev_b32 v132, 16, v131
    v_and_b32 v131, 0xffff0000, v131
    v_add_f32 v131, v132, v131
    v_add_f32 v131, v131, v133
    v_cvt_pk_bf16_f32 v246, v131, v235
    ds_write_b32 v230, v246
    s_mov_b64 exec, s[56:57]
    ds_read2_b32 v[196:197], v225 offset0:0 offset1:0
    s_mov_b64 exec, s[58:59]
    ds_read2_b32 v[198:199], v225 offset0:0 offset1:0
    s_mov_b64 exec, -1
    ds_write_b64 v245, v[248:249]
    s_mov_b64 exec, s[60:61]
    ds_write_b64 v244, v[242:243]
    s_mov_b64 exec, -1
    buffer_load_dwordx4 v[184:187], v[150:151], s[4:7], 0 idxen offen sc1
    buffer_load_dwordx4 v[188:191], v[150:151], s[4:7], 0 idxen offen offset:128 sc1
    s_sub_u32 s52, s32, 7
    s_max_i32 s52, s52, 0
    s_cmp_lt_u32 s25, 4
    s_cbranch_scc1 K_NOPRIO
    s_sub_u32 s3, s32, s31
    s_mul_i32 s3, s3, 10
    s_lshr_b32 s3, s3, 4
    s_add_u32 s3, s3, s31
    s_min_u32 s52, s52, s3
    s_setprio 1
K_NOPRIO:
    v_mfma_f32_32x32x16_bf16 v[144:159], v[192:195], v[192:195], 0
    s_waitcnt lgkmcnt(0)
    v_lshl_add_u64 v[218:219], v[218:219], 0, v[222:223]
    v_lshl_add_u64 v[220:221], v[220:221], 0, v[222:223]
    v_mfma_f32_32x32x16_bf16 v[96:111], v[196:199], v[208:211], v[96:111]
    s_waitcnt vmcnt(6)
    v_mfma_f32_32x32x16_bf16 v[96:111], v[160:163], v[200:203], v[96:111]
    v_mfma_f32_32x32x16_bf16 v[96:111], v[164:167], v[204:207], v[96:111]
    s_nop 9
.p2align 6
K2_LOOP:
    ds_read_b128 v[112:115], v218
    ds_read_b128 v[116:119], v219
    v_mfma_f32_32x32x16_bf16 v[0:15], v[192:195], v[144:147], v[0:15]
    v_exp_f32 v128, v96
    ds_read_b128 v[120:123], v220
    v_exp_f32 v129, v97
    ds_read_b128 v[124:127], v221
    v_exp_f32 v130, v98
    ds_read_b128 v[218:221], v226 offset:64
    v_mfma_f32_32x32x16_bf16 v[16:31], v[192:195], v[148:151], v[16:31]
    v_exp_f32 v131, v99
    s_mov_b64 exec, s[56:57]
    ds_read2_b32 v[196:197], v225 offset0:8 offset1:8
    s_mov_b64 exec, s[58:59]
    ds_read2_b32 v[198:199], v225 offset0:8 offset1:8
    s_mov_b64 exec, -1
    v_exp_f32 v132, v100
    s_add_u32 s3, s31, 4
    s_cmp_lt_u32 s3, s32
    s_cselect_b32 s6, 25000, 0
    v_exp_f32 v133, v101
    buffer_load_dwordx4 v[160:163], v[216:217], s[4:7], 0 idxen offen sc1
    v_mfma_f32_32x32x16_bf16 v[32:47], v[192:195], v[152:155], v[32:47]
    v_exp_f32 v134, v102
    buffer_load_dwordx4 v[164:167], v[216:217], s[4:7], 0 idxen offen offset:128 sc1
    v_exp_f32 v135, v103
    ds_read_u16 v216, v224 offset:320
    v_exp_f32 v136, v104
    ds_read_b64 v[234:235], v229 offset:512
    v_mfma_f32_32x32x16_bf16 v[48:63], v[192:195], v[156:159], v[48:63]
    v_exp_f32 v137, v105
    v_exp_f32 v138, v106
    v_exp_f32 v139, v107
    v_exp_f32 v140, v108
    v_exp_f32 v141, v109
    v_exp_f32 v142, v110
    v_exp_f32 v143, v111
    v_pk_add_f32 v[128:129], v[128:129], 1.0 op_sel_hi:[1,0]
    v_pk_add_f32 v[130:131], v[130:131], 1.0 op_sel_hi:[1,0]
    v_pk_add_f32 v[132:133], v[132:133], 1.0 op_sel_hi:[1,0]
    v_pk_add_f32 v[134:135], v[134:135], 1.0 op_sel_hi:[1,0]
    v_pk_add_f32 v[136:137], v[136:137], 1.0 op_sel_hi:[1,0]
    v_pk_add_f32 v[138:139], v[138:139], 1.0 op_sel_hi:[1,0]
    v_pk_add_f32 v[140:141], v[140:141], 1.0 op_sel_hi:[1,0]
    v_pk_add_f32 v[142:143], v[142:143], 1.0 op_sel_hi:[1,0]
    v_rcp_f32 v128, v128
    v_rcp_f32 v129, v129
    s_waitcnt vmcnt(6) lgkmcnt(0)
    v_mfma_f32_32x32x16_bf16 v[112:127], v[196:199], v[208:211], v[112:127]
    v_rcp_f32 v130, v130
    v_rcp_f32 v131, v131
    v_rcp_f32 v132, v132
    v_mfma_f32_32x32x16_bf16 v[112:127], v[168:171], v[200:203], v[112:127]
    v_rcp_f32 v133, v133
    v_rcp_f32 v134, v134
    v_rcp_f32 v135, v135
    v_mfma_f32_32x32x16_bf16 v[112:127], v[172:175], v[204:207], v[112:127]
    v_rcp_f32 v136, v136
    v_rcp_f32 v137, v137
    v_rcp_f32 v138, v138
    v_lshl_add_u64 v[218:219], v[218:219], 0, v[222:223]
    v_lshl_add_u64 v[220:221], v[220:221], 0, v[222:223]
    v_rcp_f32 v139, v139
    v_rcp_f32 v140, v140
    v_rcp_f32 v141, v141
    v_rcp_f32 v142, v142
    v_rcp_f32 v143, v143
    v_pk_mul_f32 v[128:129], v[128:129], v[96:97]
    v_pk_mul_f32 v[130:131], v[130:131], v[98:99]
    v_pk_mul_f32 v[132:133], v[132:133], v[100:101]
    v_pk_mul_f32 v[134:135], v[134:135], v[102:103]
    v_pk_mul_f32 v[136:137], v[136:137], v[104:105]
    v_pk_mul_f32 v[138:139], v[138:139], v[106:107]
    v_pk_mul_f32 v[140:141], v[140:141], v[108:109]
    v_pk_mul_f32 v[142:143], v[142:143], v[110:111]
    v_cvt_pk_bf16_f32 v144, v128, v132
    v_cvt_pk_bf16_f32 v145, v136, v140
    v_cvt_pk_bf16_f32 v148, v129, v133
    v_cvt_pk_bf16_f32 v149, v137, v141
    v_cvt_pk_bf16_f32 v152, v130, v134
    v_cvt_pk_bf16_f32 v153, v138, v142
    v_cvt_pk_bf16_f32 v156, v131, v135
    v_cvt_pk_bf16_f32 v157, v139, v143
    v_mov_b32 v245, v244
    v_and_b32 v244, 0xffff, v234
    v_bfe_u32 v246, v234, 16, 7
    v_mul_u32_u24 v244, 6, v244
    v_lshlrev_b32 v246, 4, v246
    v_and_b32 v244, -4, v244
    s_cmp_ge_u32 s31, s34
    s_cbranch_scc1 K2_XF0
K2_NF0:
    ds_read_b128 v[96:99], v218
    ds_read_b128 v[100:103], v219
    v_exp_f32 v128, v112
    ds_read_b128 v[104:107], v220
    v_exp_f32 v129, v113
    ds_read_b128 v[108:111], v221
    v_exp_f32 v130, v114
    ds_read_b128 v[218:221], v226 offset:96
    v_exp_f32 v131, v115
    s_mov_b64 exec, s[56:57]
    ds_read2_b32 v[196:197], v225 offset0:16 offset1:16
    s_mov_b64 exec, s[58:59]
    ds_read2_b32 v[198:199], v225 offset0:16 offset1:16
    s_mov_b64 exec, -1
    v_exp_f32 v132, v116
    buffer_load_dwordx2 v[236:237], v244, s[8:11], 0 offen
    v_exp_f32 v133, v117
    ds_read_b128 v[238:241], v246 offset:320
    v_exp_f32 v134, v118
    buffer_load_dwordx4 v[168:171], v[216:217], s[4:7], 0 idxen offen sc1
    v_exp_f32 v135, v119
    buffer_load_dwordx4 v[172:175], v[216:217], s[4:7], 0 idxen offen offset:128 sc1
    v_exp_f32 v136, v120
    ds_read_u16 v216, v224 offset:384
    v_exp_f32 v137, v121
    ds_read_b64_tr_b16 v[192:193], v227 offset:0
    v_exp_f32 v138, v122
    ds_read_b64_tr_b16 v[194:195], v227 offset:512
    v_exp_f32 v139, v123
    v_exp_f32 v140, v124
    v_exp_f32 v141, v125
    v_exp_f32 v142, v126
    v_exp_f32 v143, v127
    v_pk_add_f32 v[128:129], v[128:129], 1.0 op_sel_hi:[1,0]
    v_pk_add_f32 v[130:131], v[130:131], 1.0 op_sel_hi:[1,0]
    v_pk_add_f32 v[132:133], v[132:133], 1.0 op_sel_hi:[1,0]
    v_pk_add_f32 v[134:135], v[134:135], 1.0 op_sel_hi:[1,0]
    v_pk_add_f32 v[136:137], v[136:137], 1.0 op_sel_hi:[1,0]
    v_pk_add_f32 v[138:139], v[138:139], 1.0 op_sel_hi:[1,0]
    v_pk_add_f32 v[140:141], v[140:141], 1.0 op_sel_hi:[1,0]
    v_pk_add_f32 v[142:143], v[142:143], 1.0 op_sel_hi:[1,0]
    v_rcp_f32 v128, v128
    v_rcp_f32 v129, v129
    s_waitcnt vmcnt(7) lgkmcnt(0)
    v_mfma_f32_32x32x16_bf16 v[96:111], v[196:199], v[208:211], v[96:111]
    v_rcp_f32 v130, v130
    v_rcp_f32 v131, v131
    v_rcp_f32 v132, v132
    v_mfma_f32_32x32x16_bf16 v[96:111], v[176:179], v[200:203], v[96:111]
    v_rcp_f32 v133, v133
    v_rcp_f32 v134, v134
    v_rcp_f32 v135, v135
    v_mfma_f32_32x32x16_bf16 v[96:111], v[180:183], v[204:207], v[96:111]
    v_rcp_f32 v136, v136
    v_rcp_f32 v137, v137
    v_rcp_f32 v138, v138
    v_lshl_add_u64 v[218:219], v[218:219], 0, v[222:223]
    v_lshl_add_u64 v[220:221], v[220:221], 0, v[222:223]
    v_rcp_f32 v139, v139
    v_rcp_f32 v140, v140
    v_rcp_f32 v141, v141
    v_rcp_f32 v142, v142
    v_rcp_f32 v143, v143
    v_pk_mul_f32 v[128:129], v[128:129], v[112:113]
    v_pk_mul_f32 v[130:131], v[130:131], v[114:115]
    v_pk_mul_f32 v[132:133], v[132:133], v[116:117]
    v_pk_mul_f32 v[134:135], v[134:135], v[118:119]
    v_pk_mul_f32 v[136:137], v[136:137], v[120:121]
    v_pk_mul_f32 v[138:139], v[138:139], v[122:123]
    v_pk_mul_f32 v[140:141], v[140:141], v[124:125]
    v_pk_mul_f32 v[142:143], v[142:143], v[126:127]
    v_cvt_pk_bf16_f32 v146, v128, v132
    v_cvt_pk_bf16_f32 v147, v136, v140
    v_cvt_pk_bf16_f32 v150, v129, v133
    v_cvt_pk_bf16_f32 v151, v137, v141
    v_cvt_pk_bf16_f32 v154, v130, v134
    v_cvt_pk_bf16_f32 v155, v138, v142
    v_cvt_pk_bf16_f32 v158, v131, v135
    v_cvt_pk_bf16_f32 v159, v139, v143
    s_add_u32 s31, s31, 2
    s_min_u32 s3, s52, s34
    s_cmp_gt_u32 s31, s3
    s_cbranch_scc1 K2_XM1
K2_NM1:
    ds_read_b128 v[112:115], v218
    ds_read_b128 v[116:119], v219
    v_mfma_f32_32x32x16_bf16 v[0:15], v[192:195], v[144:147], v[0:15]
    v_exp_f32 v128, v96
    ds_read_b128 v[120:123], v220
    v_exp_f32 v129, v97
    ds_read_b128 v[124:127], v221
    v_exp_f32 v130, v98
    ds_read_b128 v[218:221], v226 offset:128
    v_mfma_f32_32x32x16_bf16 v[16:31], v[192:195], v[148:151], v[16:31]
    v_exp_f32 v131, v99
    s_mov_b64 exec, s[56:57]
    ds_read2_b32 v[196:197], v225 offset0:24 offset1:24
    s_mov_b64 exec, s[58:59]
    ds_read2_b32 v[198:199], v225 offset0:24 offset1:24
    s_mov_b64 exec, -1
    v_exp_f32 v132, v100
    s_add_u32 s3, s31, 4
    s_cmp_lt_u32 s3, s32
    s_cselect_b32 s6, 25000, 0
    v_exp_f32 v133, v101
    buffer_load_dwordx4 v[176:179], v[216:217], s[4:7], 0 idxen offen sc1
    v_mfma_f32_32x32x16_bf16 v[32:47], v[192:195], v[152:155], v[32:47]
    v_exp_f32 v134, v102
    buffer_load_dwordx4 v[180:183], v[216:217], s[4:7], 0 idxen offen offset:128 sc1
    v_exp_f32 v135, v103
    ds_read_u16 v216, v224 offset:448
    v_exp_f32 v136, v104
    v_mfma_f32_32x32x16_bf16 v[48:63], v[192:195], v[156:159], v[48:63]
    v_exp_f32 v137, v105
    v_exp_f32 v138, v106
    v_exp_f32 v139, v107
    v_exp_f32 v140, v108
    v_exp_f32 v141, v109
    v_exp_f32 v142, v110
    v_exp_f32 v143, v111
    v_pk_add_f32 v[128:129], v[128:129], 1.0 op_sel_hi:[1,0]
    v_pk_add_f32 v[130:131], v[130:131], 1.0 op_sel_hi:[1,0]
    v_pk_add_f32 v[132:133], v[132:133], 1.0 op_sel_hi:[1,0]
    v_pk_add_f32 v[134:135], v[134:135], 1.0 op_sel_hi:[1,0]
    v_pk_add_f32 v[136:137], v[136:137], 1.0 op_sel_hi:[1,0]
    v_pk_add_f32 v[138:139], v[138:139], 1.0 op_sel_hi:[1,0]
    v_pk_add_f32 v[140:141], v[140:141], 1.0 op_sel_hi:[1,0]
    v_pk_add_f32 v[142:143], v[142:143], 1.0 op_sel_hi:[1,0]
    v_rcp_f32 v128, v128
    v_rcp_f32 v129, v129
    s_waitcnt vmcnt(7) lgkmcnt(0)
    v_mfma_f32_32x32x16_bf16 v[112:127], v[196:199], v[208:211], v[112:127]
    v_rcp_f32 v130, v130
    v_rcp_f32 v131, v131
    v_rcp_f32 v132, v132
    v_mfma_f32_32x32x16_bf16 v[112:127], v[184:187], v[200:203], v[112:127]
    v_rcp_f32 v133, v133
    v_rcp_f32 v134, v134
    v_rcp_f32 v135, v135
    v_mfma_f32_32x32x16_bf16 v[112:127], v[188:191], v[204:207], v[112:127]
    v_rcp_f32 v136, v136
    v_rcp_f32 v137, v137
    v_rcp_f32 v138, v138
    v_lshl_add_u64 v[218:219], v[218:219], 0, v[222:223]
    v_lshl_add_u64 v[220:221], v[220:221], 0, v[222:223]
    v_rcp_f32 v139, v139
    v_rcp_f32 v140, v140
    v_rcp_f32 v141, v141
    v_rcp_f32 v142, v142
    v_rcp_f32 v143, v143
    v_pk_mul_f32 v[128:129], v[128:129], v[96:97]
    v_pk_mul_f32 v[130:131], v[130:131], v[98:99]
    v_pk_mul_f32 v[132:133], v[132:133], v[100:101]
    v_pk_mul_f32 v[134:135], v[134:135], v[102:103]
    v_pk_mul_f32 v[136:137], v[136:137], v[104:105]
    v_pk_mul_f32 v[138:139], v[138:139], v[106:107]
    v_pk_mul_f32 v[140:141], v[140:141], v[108:109]
    v_pk_mul_f32 v[142:143], v[142:143], v[110:111]
    v_cvt_pk_bf16_f32 v144, v128, v132
    v_cvt_pk_bf16_f32 v145, v136, v140
    v_cvt_pk_bf16_f32 v148, v129, v133
    v_cvt_pk_bf16_f32 v149, v137, v141
    v_cvt_pk_bf16_f32 v152, v130, v134
    v_cvt_pk_bf16_f32 v153, v138, v142
    v_cvt_pk_bf16_f32 v156, v131, v135
    v_cvt_pk_bf16_f32 v157, v139, v143
    s_cmp_ge_u32 s31, s34
    s_cbranch_scc1 K2_XF2
K2_NF2:
    ds_read_b128 v[96:99], v218
    ds_read_b128 v[100:103], v219
    v_exp_f32 v128, v112
    ds_read_b128 v[104:107], v220
    v_exp_f32 v129, v113
    ds_read_b128 v[108:111], v221
    v_exp_f32 v130, v114
    ds_read_b128 v[218:221], v226 offset:160
    v_exp_f32 v131, v115
    s_mov_b64 exec, s[56:57]
    ds_read2_b32 v[196:197], v225 offset0:32 offset1:32
    s_mov_b64 exec, s[58:59]
    ds_read2_b32 v[198:199], v225 offset0:32 offset1:32
    s_mov_b64 exec, -1
    v_exp_f32 v132, v116
    buffer_load_dwordx4 v[184:187], v[216:217], s[4:7], 0 idxen offen sc1
    v_exp_f32 v133, v117
    buffer_load_dwordx4 v[188:191], v[216:217], s[4:7], 0 idxen offen offset:128 sc1
    v_exp_f32 v134, v118
    ds_read_u16 v216, v224 offset:512
    v_exp_f32 v135, v119
    ds_read_b64_tr_b16 v[192:193], v227 offset:1024
    v_exp_f32 v136, v120
    ds_read_b64_tr_b16 v[194:195], v227 offset:1536
    v_exp_f32 v137, v121
    v_exp_f32 v138, v122
    v_exp_f32 v139, v123
    v_exp_f32 v140, v124
    v_exp_f32 v141, v125
    v_exp_f32 v142, v126
    v_exp_f32 v143, v127
    v_pk_add_f32 v[128:129], v[128:129], 1.0 op_sel_hi:[1,0]
    v_pk_add_f32 v[130:131], v[130:131], 1.0 op_sel_hi:[1,0]
    v_pk_add_f32 v[132:133], v[132:133], 1.0 op_sel_hi:[1,0]
    v_pk_add_f32 v[134:135], v[134:135], 1.0 op_sel_hi:[1,0]
    v_pk_add_f32 v[136:137], v[136:137], 1.0 op_sel_hi:[1,0]
    v_pk_add_f32 v[138:139], v[138:139], 1.0 op_sel_hi:[1,0]
    v_pk_add_f32 v[140:141], v[140:141], 1.0 op_sel_hi:[1,0]
    v_pk_add_f32 v[142:143], v[142:143], 1.0 op_sel_hi:[1,0]
    v_rcp_f32 v128, v128
    v_rcp_f32 v129, v129
    s_waitcnt vmcnt(7) lgkmcnt(0)
    v_mfma_f32_32x32x16_bf16 v[96:111], v[196:199], v[208:211], v[96:111]
    v_rcp_f32 v130, v130
    v_rcp_f32 v131, v131
    v_rcp_f32 v132, v132
    v_mfma_f32_32x32x16_bf16 v[96:111], v[160:163], v[200:203], v[96:111]
    v_rcp_f32 v133, v133
    v_rcp_f32 v134, v134
    v_rcp_f32 v135, v135
    v_mfma_f32_32x32x16_bf16 v[96:111], v[164:167], v[204:207], v[96:111]
    v_rcp_f32 v136, v136
    v_rcp_f32 v137, v137
    v_rcp_f32 v138, v138
    v_lshl_add_u64 v[218:219], v[218:219], 0, v[222:223]
    v_lshl_add_u64 v[220:221], v[220:221], 0, v[222:223]
    v_rcp_f32 v139, v139
    v_rcp_f32 v140, v140
    v_rcp_f32 v141, v141
    v_rcp_f32 v142, v142
    v_rcp_f32 v143, v143
    v_pk_mul_f32 v[128:129], v[128:129], v[112:113]
    v_pk_mul_f32 v[130:131], v[130:131], v[114:115]
    v_pk_mul_f32 v[132:133], v[132:133], v[116:117]
    v_pk_mul_f32 v[134:135], v[134:135], v[118:119]
    v_pk_mul_f32 v[136:137], v[136:137], v[120:121]
    v_pk_mul_f32 v[138:139], v[138:139], v[122:123]
    v_pk_mul_f32 v[140:141], v[140:141], v[124:125]
    v_pk_mul_f32 v[142:143], v[142:143], v[126:127]
    v_cvt_pk_bf16_f32 v146, v128, v132
    v_cvt_pk_bf16_f32 v147, v136, v140
    v_cvt_pk_bf16_f32 v150, v129, v133
    v_cvt_pk_bf16_f32 v151, v137, v141
    v_cvt_pk_bf16_f32 v154, v130, v134
    v_cvt_pk_bf16_f32 v155, v138, v142
    v_cvt_pk_bf16_f32 v158, v131, v135
    v_cvt_pk_bf16_f32 v159, v139, v143
    s_add_u32 s31, s31, 2
    s_min_u32 s3, s52, s34
    s_cmp_gt_u32 s31, s3
    s_cbranch_scc1 K2_XM3
K2_NM3:
    ds_read_b128 v[112:115], v218
    ds_read_b128 v[116:119], v219
    v_mfma_f32_32x32x16_bf16 v[0:15], v[192:195], v[144:147], v[0:15]
    v_exp_f32 v128, v96
    ds_read_b128 v[120:123], v220
    v_exp_f32 v129, v97
    ds_read_b128 v[124:127], v221
    v_exp_f32 v130, v98
    ds_read_b128 v[218:221], v226 offset:192
    v_mfma_f32_32x32x16_bf16 v[16:31], v[192:195], v[148:151], v[16:31]
    v_exp_f32 v131, v99
    s_mov_b64 exec, s[56:57]
    ds_read2_b32 v[196:197], v225 offset0:40 offset1:40
    s_mov_b64 exec, s[58:59]
    ds_read2_b32 v[198:199], v225 offset0:40 offset1:40
    s_mov_b64 exec, -1
    v_exp_f32 v132, v100
    s_add_u32 s3, s31, 4
    s_cmp_lt_u32 s3, s32
    s_cselect_b32 s6, 25000, 0
    v_exp_f32 v133, v101
    buffer_load_dwordx4 v[160:163], v[216:217], s[4:7], 0 idxen offen sc1
    v_mfma_f32_32x32x16_bf16 v[32:47], v[192:195], v[152:155], v[32:47]
    v_exp_f32 v134, v102
    buffer_load_dwordx4 v[164:167], v[216:217], s[4:7], 0 idxen offen offset:128 sc1
    v_exp_f32 v135, v103
    ds_read_u16 v216, v224 offset:576
    v_exp_f32 v136, v104
    v_mfma_f32_32x32x16_bf16 v[48:63], v[192:195], v[156:159], v[48:63]
    v_exp_f32 v137, v105
    v_exp_f32 v138, v106
    v_exp_f32 v139, v107
    v_exp_f32 v140, v108
    v_exp_f32 v141, v109
    v_exp_f32 v142, v110
    v_exp_f32 v143, v111
    v_pk_add_f32 v[128:129], v[128:129], 1.0 op_sel_hi:[1,0]
    v_pk_add_f32 v[130:131], v[130:131], 1.0 op_sel_hi:[1,0]
    v_pk_add_f32 v[132:133], v[132:133], 1.0 op_sel_hi:[1,0]
    v_pk_add_f32 v[134:135], v[134:135], 1.0 op_sel_hi:[1,0]
    v_pk_add_f32 v[136:137], v[136:137], 1.0 op_sel_hi:[1,0]
    v_pk_add_f32 v[138:139], v[138:139], 1.0 op_sel_hi:[1,0]
    v_pk_add_f32 v[140:141], v[140:141], 1.0 op_sel_hi:[1,0]
    v_pk_add_f32 v[142:143], v[142:143], 1.0 op_sel_hi:[1,0]
    v_rcp_f32 v128, v128
    v_rcp_f32 v129, v129
    s_waitcnt vmcnt(6) lgkmcnt(0)
    v_mfma_f32_32x32x16_bf16 v[112:127], v[196:199], v[208:211], v[112:127]
    v_rcp_f32 v130, v130
    v_rcp_f32 v131, v131
    v_rcp_f32 v132, v132
    v_mfma_f32_32x32x16_bf16 v[112:127], v[168:171], v[200:203], v[112:127]
    v_rcp_f32 v133, v133
    v_rcp_f32 v134, v134
    v_rcp_f32 v135, v135
    v_mfma_f32_32x32x16_bf16 v[112:127], v[172:175], v[204:207], v[112:127]
    v_rcp_f32 v136, v136
    v_rcp_f32 v137, v137
    v_rcp_f32 v138, v138
    v_lshl_add_u64 v[218:219], v[218:219], 0, v[222:223]
    v_lshl_add_u64 v[220:221], v[220:221], 0, v[222:223]
    v_rcp_f32 v139, v139
    v_rcp_f32 v140, v140
    v_rcp_f32 v141, v141
    v_rcp_f32 v142, v142
    v_rcp_f32 v143, v143
    v_pk_mul_f32 v[128:129], v[128:129], v[96:97]
    v_pk_mul_f32 v[130:131], v[130:131], v[98:99]
    v_pk_mul_f32 v[132:133], v[132:133], v[100:101]
    v_pk_mul_f32 v[134:135], v[134:135], v[102:103]
    v_pk_mul_f32 v[136:137], v[136:137], v[104:105]
    v_pk_mul_f32 v[138:139], v[138:139], v[106:107]
    v_pk_mul_f32 v[140:141], v[140:141], v[108:109]
    v_pk_mul_f32 v[142:143], v[142:143], v[110:111]
    v_cvt_pk_bf16_f32 v144, v128, v132
    v_cvt_pk_bf16_f32 v145, v136, v140
    v_cvt_pk_bf16_f32 v148, v129, v133
    v_cvt_pk_bf16_f32 v149, v137, v141
    v_cvt_pk_bf16_f32 v152, v130, v134
    v_cvt_pk_bf16_f32 v153, v138, v142
    v_cvt_pk_bf16_f32 v156, v131, v135
    v_cvt_pk_bf16_f32 v157, v139, v143
    s_cmp_ge_u32 s31, s34
    s_cbranch_scc1 K2_XF4
K2_NF4:
    ds_read_b128 v[96:99], v218
    ds_read_b128 v[100:103], v219
    v_exp_f32 v128, v112
    ds_read_b128 v[104:107], v220
    v_exp_f32 v129, v113
    ds_read_b128 v[108:111], v221
    v_exp_f32 v130, v114
    ds_read_b128 v[218:221], v226 offset:224
    v_exp_f32 v131, v115
    s_mov_b64 exec, s[56:57]
    ds_read2_b32 v[196:197], v225 offset0:48 offset1:48
    s_mov_b64 exec, s[58:59]
    ds_read2_b32 v[198:199], v225 offset0:48 offset1:48
    s_mov_b64 exec, -1
    v_exp_f32 v132, v116
    buffer_load_dwordx4 v[168:171], v[216:217], s[4:7], 0 idxen offen sc1
    v_exp_f32 v133, v117
    buffer_load_dwordx4 v[172:175], v[216:217], s[4:7], 0 idxen offen offset:128 sc1
    v_exp_f32 v134, v118
    ds_read_u16 v216, v224 offset:640
    v_exp_f32 v135, v119
    ds_read_b64_tr_b16 v[192:193], v227 offset:2048
    v_exp_f32 v136, v120
    ds_read_b64_tr_b16 v[194:195], v227 offset:2560
    v_exp_f32 v137, v121
    v_exp_f32 v138, v122
    v_exp_f32 v139, v123
    v_exp_f32 v140, v124
    v_exp_f32 v141, v125
    v_exp_f32 v142, v126
    v_exp_f32 v143, v127
    v_pk_add_f32 v[128:129], v[128:129], 1.0 op_sel_hi:[1,0]
    v_pk_add_f32 v[130:131], v[130:131], 1.0 op_sel_hi:[1,0]
    v_pk_add_f32 v[132:133], v[132:133], 1.0 op_sel_hi:[1,0]
    v_pk_add_f32 v[134:135], v[134:135], 1.0 op_sel_hi:[1,0]
    v_pk_add_f32 v[136:137], v[136:137], 1.0 op_sel_hi:[1,0]
    v_pk_add_f32 v[138:139], v[138:139], 1.0 op_sel_hi:[1,0]
    v_pk_add_f32 v[140:141], v[140:141], 1.0 op_sel_hi:[1,0]
    v_pk_add_f32 v[142:143], v[142:143], 1.0 op_sel_hi:[1,0]
    v_rcp_f32 v128, v128
    v_rcp_f32 v129, v129
    s_waitcnt vmcnt(6) lgkmcnt(0)
    v_mfma_f32_32x32x16_bf16 v[96:111], v[196:199], v[208:211], v[96:111]
    v_rcp_f32 v130, v130
    v_rcp_f32 v131, v131
    v_rcp_f32 v132, v132
    v_mfma_f32_32x32x16_bf16 v[96:111], v[176:179], v[200:203], v[96:111]
    v_rcp_f32 v133, v133
    v_rcp_f32 v134, v134
    v_rcp_f32 v135, v135
    v_mfma_f32_32x32x16_bf16 v[96:111], v[180:183], v[204:207], v[96:111]
    v_rcp_f32 v136, v136
    v_rcp_f32 v137, v137
    v_rcp_f32 v138, v138
    v_lshl_add_u64 v[218:219], v[218:219], 0, v[222:223]
    v_lshl_add_u64 v[220:221], v[220:221], 0, v[222:223]
    v_rcp_f32 v139, v139
    v_rcp_f32 v140, v140
    v_rcp_f32 v141, v141
    v_rcp_f32 v142, v142
    v_rcp_f32 v143, v143
    v_pk_mul_f32 v[128:129], v[128:129], v[112:113]
    v_pk_mul_f32 v[130:131], v[130:131], v[114:115]
    v_pk_mul_f32 v[132:133], v[132:133], v[116:117]
    v_pk_mul_f32 v[134:135], v[134:135], v[118:119]
    v_pk_mul_f32 v[136:137], v[136:137], v[120:121]
    v_pk_mul_f32 v[138:139], v[138:139], v[122:123]
    v_pk_mul_f32 v[140:141], v[140:141], v[124:125]
    v_pk_mul_f32 v[142:143], v[142:143], v[126:127]
    v_cvt_pk_bf16_f32 v146, v128, v132
    v_cvt_pk_bf16_f32 v147, v136, v140
    v_cvt_pk_bf16_f32 v150, v129, v133
    v_cvt_pk_bf16_f32 v151, v137, v141
    v_cvt_pk_bf16_f32 v154, v130, v134
    v_cvt_pk_bf16_f32 v155, v138, v142
    v_cvt_pk_bf16_f32 v158, v131, v135
    v_cvt_pk_bf16_f32 v159, v139, v143
    v_lshlrev_b32 v128, 4, v234
    v_cmp_lt_i32 s[60:61], -1, v234
    v_alignbit_b32 v129, v237, v236, v128
    v_lshrrev_b32 v130, v128, v237
    v_lshlrev_b32 v131, 16, v129
    v_and_b32 v132, 0xffff0000, v129
    v_lshlrev_b32 v133, 16, v130
    v_sub_f32 v131, v238, v131
    v_sub_f32 v132, v239, v132
    v_sub_f32 v133, v240, v133
    v_cvt_pk_bf16_f32 v242, 1.0, v131
    v_cvt_pk_bf16_f32 v243, v132, v133
    v_bfe_u32 v134, v234, 16, 7
    v_bfe_u32 v135, v234, 16, 3
    v_and_b32 v131, 0xffff0000, v242
    v_lshlrev_b32 v132, 16, v243
    v_and_b32 v133, 0xffff0000, v243
    v_mul_f32 v131, v131, v131
    v_mul_f32 v132, v132, v132
    v_mul_f32 v133, v133, v133
    v_mul_u32_u24 v241, 528, v134
    v_lshl_add_u32 v244, v135, 3, v228
    v_cvt_pk_bf16_f32 v131, v131, v132
    v_cvt_pk_bf16_f32 v133, 0, v133
    v_lshlrev_b32 v132, 16, v131
    v_and_b32 v131, 0xffff0000, v131
    v_add_f32 v131, v132, v131
    v_add_f32 v131, v131, v133
    v_cvt_pk_bf16_f32 v246, v131, v235
    ds_write_b32 v230, v241 offset:256
    s_add_u32 s31, s31, 2
    s_min_u32 s3, s52, s34
    s_cmp_gt_u32 s31, s3
    s_cbranch_scc1 K2_XM5
K2_NM5:
    ds_read_b128 v[112:115], v218
    ds_read_b128 v[116:119], v219
    v_mfma_f32_32x32x16_bf16 v[0:15], v[192:195], v[144:147], v[0:15]
    v_exp_f32 v128, v96
    ds_read_b128 v[120:123], v220
    v_exp_f32 v129, v97
    ds_read_b128 v[124:127], v221
    v_exp_f32 v130, v98
    ds_read_b128 v[218:221], v226 offset:0
    v_mfma_f32_32x32x16_bf16 v[16:31], v[192:195], v[148:151], v[16:31]
    v_exp_f32 v131, v99
    s_mov_b64 exec, s[56:57]
    ds_read2_b32 v[196:197], v225 offset0:56 offset1:56
    s_mov_b64 exec, s[58:59]
    ds_read2_b32 v[198:199], v225 offset0:56 offset1:56
    s_mov_b64 exec, -1
    v_exp_f32 v132, v100
    ds_write_b32 v230, v246
    v_exp_f32 v133, v101
    s_add_u32 s3, s31, 4
    s_cmp_lt_u32 s3, s32
    s_cselect_b32 s6, 25000, 0
    v_mfma_f32_32x32x16_bf16 v[32:47], v[192:195], v[152:155], v[32:47]
    v_exp_f32 v134, v102
    buffer_load_dwordx4 v[176:179], v[216:217], s[4:7], 0 idxen offen sc1
    v_exp_f32 v135, v103
    buffer_load_dwordx4 v[180:183], v[216:217], s[4:7], 0 idxen offen offset:128 sc1
    v_exp_f32 v136, v104
    ds_read_u16 v216, v224 offset:704
    v_mfma_f32_32x32x16_bf16 v[48:63], v[192:195], v[156:159], v[48:63]
    v_exp_f32 v137, v105
    v_exp_f32 v138, v106
    v_exp_f32 v139, v107
    v_exp_f32 v140, v108
    v_exp_f32 v141, v109
    v_exp_f32 v142, v110
    v_exp_f32 v143, v111
    v_pk_add_f32 v[128:129], v[128:129], 1.0 op_sel_hi:[1,0]
    v_pk_add_f32 v[130:131], v[130:131], 1.0 op_sel_hi:[1,0]
    v_pk_add_f32 v[132:133], v[132:133], 1.0 op_sel_hi:[1,0]
    v_pk_add_f32 v[134:135], v[134:135], 1.0 op_sel_hi:[1,0]
    v_pk_add_f32 v[136:137], v[136:137], 1.0 op_sel_hi:[1,0]
    v_pk_add_f32 v[138:139], v[138:139], 1.0 op_sel_hi:[1,0]
    v_pk_add_f32 v[140:141], v[140:141], 1.0 op_sel_hi:[1,0]
    v_pk_add_f32 v[142:143], v[142:143], 1.0 op_sel_hi:[1,0]
    v_rcp_f32 v128, v128
    v_rcp_f32 v129, v129
    s_waitcnt vmcnt(6) lgkmcnt(0)
    v_mfma_f32_32x32x16_bf16 v[112:127], v[196:199], v[208:211], v[112:127]
    v_rcp_f32 v130, v130
    v_rcp_f32 v131, v131
    v_rcp_f32 v132, v132
    v_mfma_f32_32x32x16_bf16 v[112:127], v[184:187], v[200:203], v[112:127]
    v_rcp_f32 v133, v133
    v_rcp_f32 v134, v134
    v_rcp_f32 v135, v135
    v_mfma_f32_32x32x16_bf16 v[112:127], v[188:191], v[204:207], v[112:127]
    v_rcp_f32 v136, v136
    v_rcp_f32 v137, v137
    v_rcp_f32 v138, v138
    v_lshl_add_u64 v[218:219], v[218:219], 0, v[222:223]
    v_lshl_add_u64 v[220:221], v[220:221], 0, v[222:223]
    v_rcp_f32 v139, v139
    v_rcp_f32 v140, v140
    v_rcp_f32 v141, v141
    v_rcp_f32 v142, v142
    v_rcp_f32 v143, v143
    v_pk_mul_f32 v[128:129], v[128:129], v[96:97]
    v_pk_mul_f32 v[130:131], v[130:131], v[98:99]
    v_pk_mul_f32 v[132:133], v[132:133], v[100:101]
    v_pk_mul_f32 v[134:135], v[134:135], v[102:103]
    v_pk_mul_f32 v[136:137], v[136:137], v[104:105]
    v_pk_mul_f32 v[138:139], v[138:139], v[106:107]
    v_pk_mul_f32 v[140:141], v[140:141], v[108:109]
    v_pk_mul_f32 v[142:143], v[142:143], v[110:111]
    v_cvt_pk_bf16_f32 v144, v128, v132
    v_cvt_pk_bf16_f32 v145, v136, v140
    v_cvt_pk_bf16_f32 v148, v129, v133
    v_cvt_pk_bf16_f32 v149, v137, v141
    v_cvt_pk_bf16_f32 v152, v130, v134
    v_cvt_pk_bf16_f32 v153, v138, v142
    v_cvt_pk_bf16_f32 v156, v131, v135
    v_cvt_pk_bf16_f32 v157, v139, v143
    s_cmp_ge_u32 s31, s34
    s_cbranch_scc1 K2_XF6
K2_NF6:
    ds_read_b128 v[96:99], v218
    ds_read_b128 v[100:103], v219
    v_exp_f32 v128, v112
    ds_read_b128 v[104:107], v220
    v_exp_f32 v129, v113
    ds_read_b128 v[108:111], v221
    v_exp_f32 v130, v114
    ds_read_b128 v[218:221], v226 offset:32
    v_exp_f32 v131, v115
    s_mov_b64 exec, s[56:57]
    ds_read2_b32 v[196:197], v225 offset0:0 offset1:0
    s_mov_b64 exec, s[58:59]
    ds_read2_b32 v[198:199], v225 offset0:0 offset1:0
    s_mov_b64 exec, -1
    v_exp_f32 v132, v116
    buffer_load_dwordx4 v[184:187], v[216:217], s[4:7], 0 idxen offen sc1
    v_exp_f32 v133, v117
    buffer_load_dwordx4 v[188:191], v[216:217], s[4:7], 0 idxen offen offset:128 sc1
    v_exp_f32 v134, v118
    ds_read_u16 v216, v224 offset:768
    v_exp_f32 v135, v119
    ds_read_b64_tr_b16 v[192:193], v227 offset:3072
    v_exp_f32 v136, v120
    ds_read_b64_tr_b16 v[194:195], v227 offset:3584
    v_exp_f32 v137, v121
    ds_write_b64 v245, v[248:249]
    v_exp_f32 v138, v122
    s_mov_b64 exec, s[60:61]
    ds_write_b64 v244, v[242:243]
    s_mov_b64 exec, -1
    v_exp_f32 v139, v123
    v_exp_f32 v140, v124
    v_exp_f32 v141, v125
    v_exp_f32 v142, v126
    v_exp_f32 v143, v127
    v_pk_add_f32 v[128:129], v[128:129], 1.0 op_sel_hi:[1,0]
    v_pk_add_f32 v[130:131], v[130:131], 1.0 op_sel_hi:[1,0]
    v_pk_add_f32 v[132:133], v[132:133], 1.0 op_sel_hi:[1,0]
    v_pk_add_f32 v[134:135], v[134:135], 1.0 op_sel_hi:[1,0]
    v_pk_add_f32 v[136:137], v[136:137], 1.0 op_sel_hi:[1,0]
    v_pk_add_f32 v[138:139], v[138:139], 1.0 op_sel_hi:[1,0]
    v_pk_add_f32 v[140:141], v[140:141], 1.0 op_sel_hi:[1,0]
    v_pk_add_f32 v[142:143], v[142:143], 1.0 op_sel_hi:[1,0]
    v_rcp_f32 v128, v128
    v_rcp_f32 v129, v129
    s_waitcnt vmcnt(6) lgkmcnt(0)
    v_mfma_f32_32x32x16_bf16 v[96:111], v[196:199], v[208:211], v[96:111]
    v_rcp_f32 v130, v130
    v_rcp_f32 v131, v131
    v_rcp_f32 v132, v132
    v_mfma_f32_32x32x16_bf16 v[96:111], v[160:163], v[200:203], v[96:111]
    v_rcp_f32 v133, v133
    v_rcp_f32 v134, v134
    v_rcp_f32 v135, v135
    v_mfma_f32_32x32x16_bf16 v[96:111], v[164:167], v[204:207], v[96:111]
    v_rcp_f32 v136, v136
    v_rcp_f32 v137, v137
    v_rcp_f32 v138, v138
    v_lshl_add_u64 v[218:219], v[218:219], 0, v[222:223]
    v_lshl_add_u64 v[220:221], v[220:221], 0, v[222:223]
    v_rcp_f32 v139, v139
    v_rcp_f32 v140, v140
    v_rcp_f32 v141, v141
    v_rcp_f32 v142, v142
    v_rcp_f32 v143, v143
    v_pk_mul_f32 v[128:129], v[128:129], v[112:113]
    v_pk_mul_f32 v[130:131], v[130:131], v[114:115]
    v_pk_mul_f32 v[132:133], v[132:133], v[116:117]
    v_pk_mul_f32 v[134:135], v[134:135], v[118:119]
    v_pk_mul_f32 v[136:137], v[136:137], v[120:121]
    v_pk_mul_f32 v[138:139], v[138:139], v[122:123]
    v_pk_mul_f32 v[140:141], v[140:141], v[124:125]
    v_pk_mul_f32 v[142:143], v[142:143], v[126:127]
    v_cvt_pk_bf16_f32 v146, v128, v132
    v_cvt_pk_bf16_f32 v147, v136, v140
    v_cvt_pk_bf16_f32 v150, v129, v133
    v_cvt_pk_bf16_f32 v151, v137, v141
    v_cvt_pk_bf16_f32 v154, v130, v134
    v_cvt_pk_bf16_f32 v155, v138, v142
    v_cvt_pk_bf16_f32 v158, v131, v135
    v_cvt_pk_bf16_f32 v159, v139, v143
    v_add_u32 v224, 512, v224
    v_add_u32 v229, 512, v229
    s_add_u32 s31, s31, 2
    s_min_u32 s3, s52, s34
    s_cmp_gt_u32 s31, s3
    s_cbranch_scc1 K2_XM7
K2_NM7:
    s_branch K2_LOOP
K2_XF0:
    s_call_b64 s[98:99], K2_EDGE
    s_branch K2_NF0
K2_XM1:
    s_cmp_gt_u32 s31, s34
    s_cbranch_scc0 K2_XN1
    v_mov_b64 v[252:253], v[194:195]
    v_mov_b64 v[194:195], 0
K2_XN1:
    s_cmp_lt_u32 s31, s32
    s_cbranch_scc0 K2_DRAIN
    s_cmp_gt_u32 s31, s52
    s_cbranch_scc0 K2_NM1
    s_call_b64 s[54:55], K2_EVENT
    s_branch K2_NM1
K2_XF2:
    s_call_b64 s[98:99], K2_EDGE
    s_branch K2_NF2
K2_XM3:
    s_cmp_gt_u32 s31, s34
    s_cbranch_scc0 K2_XN3
    v_mov_b64 v[252:253], v[194:195]
    v_mov_b64 v[194:195], 0
K2_XN3:
    s_cmp_lt_u32 s31, s32
    s_cbranch_scc0 K2_DRAIN
    s_cmp_gt_u32 s31, s52
    s_cbranch_scc0 K2_NM3
    s_call_b64 s[54:55], K2_EVENT
    s_branch K2_NM3
K2_XF4:
    s_call_b64 s[98:99], K2_EDGE
    s_branch K2_NF4
K2_XM5:
    s_cmp_gt_u32 s31, s34
    s_cbranch_scc0 K2_XN5
    v_mov_b64 v[252:253], v[194:195]
    v_mov_b64 v[194:195], 0
K2_XN5:
    s_cmp_lt_u32 s31, s32
    s_cbranch_scc0 K2_DRAIN
    s_cmp_gt_u32 s31, s52
    s_cbranch_scc0 K2_NM5
    s_call_b64 s[54:55], K2_EVENT
    s_branch K2_NM5
K2_XF6:
    s_call_b64 s[98:99], K2_EDGE
    s_branch K2_NF6
K2_XM7:
    s_cmp_gt_u32 s31, s34
    s_cbranch_scc0 K2_XN7
    v_mov_b64 v[252:253], v[194:195]
    v_mov_b64 v[194:195], 0
K2_XN7:
    s_cmp_lt_u32 s31, s32
    s_cbranch_scc0 K2_DRAIN
    s_cmp_gt_u32 s31, s52
    s_cbranch_scc0 K2_NM7
    s_call_b64 s[54:55], K2_EVENT
    s_branch K2_NM7
K2_DRAIN:
    s_waitcnt vmcnt(4)
    v_mfma_f32_32x32x16_bf16 v[0:15], v[192:195], v[144:147], v[0:15]
    v_mfma_f32_32x32x16_bf16 v[16:31], v[192:195], v[148:151], v[16:31]
    v_mfma_f32_32x32x16_bf16 v[32:47], v[192:195], v[152:155], v[32:47]
    v_mfma_f32_32x32x16_bf16 v[48:63], v[192:195], v[156:159], v[48:63]
    s_cmp_gt_u32 s31, s34
    s_cbranch_scc0 K2_DR1
    s_nop 9
    s_call_b64 s[98:99], K2_EDGE
    s_cmp_ge_u32 s33, 13
    s_cbranch_scc1 K2_WAVE_DONE
K2_DR1:
    s_cmp_eq_u32 s31, s34
    s_cselect_b32 s49, s49, 2
    s_cselect_b32 s50, 0, 1
    s_mov_b32 s97, s31
    s_mov_b32 s52, 1
    s_branch K2_WD1
K2_WAVE_DONE:
    s_mov_b32 s52, 0
K2_WD1:
    s_cmp_lg_u32 s27, 0
    s_cselect_b32 s3, 3, 0
    s_cmp_lt_u32 s28, s3
    s_cselect_b32 s85, 1, 0
    s_or_b32 s3, s85, s30
    s_cbranch_scc1 K2_NOPRE0
    v_lshlrev_b32 v251, 4, v250
    s_lshl_b32 s82, s25, 12
    v_and_b32 v252, 31, v250
    v_lshrrev_b32 v253, 5, v250
    buffer_load_dwordx4 v[160:163], v251, s[44:47], s82 offen offset:0
    buffer_load_dwordx4 v[164:167], v251, s[44:47], s82 offen offset:1024
    buffer_load_dwordx4 v[168:171], v251, s[44:47], s82 offen offset:2048
    buffer_load_dwordx4 v[172:175], v251, s[44:47], s82 offen offset:3072
    v_lshlrev_b32 v218, 10, v253
    v_lshl_add_u32 v218, v252, 2, v218
    s_lshr_b32 s3, s25, 1
    s_lshl_b32 s3, s3, 5
    s_min_u32 s3, s3, 81
    s_lshl_b32 s58, s3, 8
    s_and_b32 s84, s25, 1
    s_lshl_b32 s83, s84, 7
    s_add_u32 s58, s58, s83
    s_add_u32 s59, s58, 4096
    buffer_load_dword v192, v218, s[16:19], s58 offen offset:0
    buffer_load_dword v193, v218, s[16:19], s58 offen offset:256
    buffer_load_dword v194, v218, s[16:19], s58 offen offset:512
    buffer_load_dword v195, v218, s[16:19], s58 offen offset:768
    buffer_load_dword v196, v218, s[16:19], s58 offen offset:2048
    buffer_load_dword v197, v218, s[16:19], s58 offen offset:2304
    buffer_load_dword v198, v218, s[16:19], s58 offen offset:2560
    buffer_load_dword v199, v218, s[16:19], s58 offen offset:2816
    buffer_load_dword v200, v218, s[16:19], s59 offen offset:0
    buffer_load_dword v201, v218, s[16:19], s59 offen offset:256
    buffer_load_dword v202, v218, s[16:19], s59 offen offset:512
    buffer_load_dword v203, v218, s[16:19], s59 offen offset:768
    buffer_load_dword v204, v218, s[16:19], s59 offen offset:2048
    buffer_load_dword v205, v218, s[16:19], s59 offen offset:2304
    buffer_load_dword v206, v218, s[16:19], s59 offen offset:2560
    buffer_load_dword v207, v218, s[16:19], s59 offen offset:2816
    v_add_u32 v252, s3, v252
    v_mul_u32_u24 v252, 528, v252
    v_lshl_add_u32 v252, v253, 5, v252
    v_lshl_add_u32 v251, v253, 13, v247
    v_xor_b32 v253, 64, v251
    v_add_u32 v251, 129408, v251
    v_add_u32 v253, 129408, v253
    s_mov_b32 s80, 0xbf317218
    s_mov_b32 s81, 0xbf317218
    v_lshrrev_b32 v104, 4, v250
    v_bfe_u32 v105, v250, 3, 1
    v_lshlrev_b32 v105, 1, v105
    v_xor_b32 v105, v105, v104
    v_lshlrev_b32 v104, 8, v104
    v_lshl_add_u32 v104, v105, 6, v104
    v_and_b32 v105, 7, v250
    v_lshl_add_u32 v104, v105, 3, v104
    v_xor_b32 v105, 64, v104
    s_add_u32 s82, s82, 129408
    v_add_u32 v104, s82, v104
    v_add_u32 v105, s82, v105
K2_NOPRE0:
    s_nop 3
    s_cmp_eq_u32 s52, 0
    s_cbranch_scc1 K2_NOFL
    s_call_b64 s[54:55], K2_FLUSH
K2_NOFL:
    s_or_b32 s3, s85, s30
    s_cbranch_scc1 K2_NOD
    s_mov_b32 s82, 0x05040100
    s_mov_b32 s83, 0x07060302
    s_waitcnt vmcnt(16)
    v_perm_b32 v96, v161, v160, s82
    v_perm_b32 v97, v163, v162, s82
    v_perm_b32 v98, v161, v160, s83
    v_perm_b32 v99, v163, v162, s83
    ds_write_b64 v104, v[96:97] offset:0
    ds_write_b64 v105, v[98:99] offset:0
    v_perm_b32 v100, v165, v164, s82
    v_perm_b32 v101, v167, v166, s82
    v_perm_b32 v102, v165, v164, s83
    v_perm_b32 v103, v167, v166, s83
    ds_write_b64 v104, v[100:101] offset:1024
    ds_write_b64 v105, v[102:103] offset:1024
    v_perm_b32 v96, v169, v168, s82
    v_perm_b32 v97, v171, v170, s82
    v_perm_b32 v98, v169, v168, s83
    v_perm_b32 v99, v171, v170, s83
    ds_write_b64 v104, v[96:97] offset:2048
    ds_write_b64 v105, v[98:99] offset:2048
    v_perm_b32 v100, v173, v172, s82
    v_perm_b32 v101, v175, v174, s82
    v_perm_b32 v102, v173, v172, s83
    v_perm_b32 v103, v175, v174, s83
    ds_write_b64 v104, v[100:101] offset:3072
    ds_write_b64 v105, v[102:103] offset:3072
    s_cmp_eq_u32 s51, 0
    s_cbranch_scc0 K2_NOD
    s_cmp_eq_u32 s50, 0
    s_cbranch_scc1 K2_F3
    s_lshl_b32 s3, s48, 2
    v_mov_b32 v130, s3
K2_TW:
    ds_read_b32 v131, v130 offset:260
    s_waitcnt lgkmcnt(0)
    v_readfirstlane_b32 s3, v131
    s_nop 3
    s_cmp_eq_u32 s3, 0
    s_cbranch_scc1 K2_TW
    s_branch K2_FAST
K2_NOD:
K2_NOPRE:
    s_waitcnt lgkmcnt(0)
    s_barrier
    s_mov_b32 s34, 0
K2_TAILS:
    s_cmp_eq_u32 s51, 0
    s_cselect_b32 s3, s25, s34
    s_cmp_eq_u32 s3, s25
    s_cselect_b32 s3, s50, 0
    s_cmp_eq_u32 s3, 0
    s_cbranch_scc1 K2_NOTAIL
    s_call_b64 s[54:55], K2_FLUSH2
K2_NOTAIL:
    s_cmp_eq_u32 s51, 0
    s_cbranch_scc1 K2_TAILD
    s_add_u32 s34, s34, 1
    s_cmp_lt_u32 s34, 8
    s_cbranch_scc0 K2_TAILD
    s_barrier
    s_branch K2_TAILS
K2_TAILD:
    s_or_b32 s3, s85, s30
    s_cbranch_scc0 K2_EPI
    s_add_u32 s28, s28, 1
    s_cmp_lg_u32 s85, 0
    s_cbranch_scc1 K2_NEXT
    s_mov_b32 s27, 0
    s_mov_b32 s28, 0
    s_add_u32 s29, s29, 24
K2_NEXT:
    s_mov_b32 s26, 1
    s_waitcnt vmcnt(0) lgkmcnt(0)
    s_barrier
    s_cmp_eq_u32 s25, 4
    s_cbranch_scc0 K2_NEXT1
    s_call_b64 s[54:55], K_LISTINIT
    v_mov_b32 v160, 0
    v_lshlrev_b32 v161, 2, v250
    ds_write_b32 v161, v160 offset:0
    ds_write_b32 v161, v160 offset:64
    s_waitcnt lgkmcnt(0)
K2_NEXT1:
    s_mov_b32 s53, 0
    s_barrier
    s_branch K_ROUND
K2_OVER:
    s_mov_b32 s27, 1
    s_mov_b32 s28, 0
    s_branch K2_NEXT
K_LISTINIT:
    v_bfrev_b32 v120, 1
    v_mov_b32 v121, 0
    v_bfrev_b32 v122, 1
    v_mov_b32 v123, 0
    v_lshlrev_b32 v124, 4, v250
    v_add_u32 v124, 112000, v124
    ds_write_b128 v124, v[120:123] offset:0
    ds_write_b128 v124, v[120:123] offset:1024
    ds_write_b128 v124, v[120:123] offset:2048
    ds_write_b128 v124, v[120:123] offset:3072
    ds_write_b128 v124, v[120:123] offset:4096
    ds_write_b128 v124, v[120:123] offset:5120
    ds_write_b128 v124, v[120:123] offset:6144
    ds_write_b128 v124, v[120:123] offset:7168
    ds_write_b128 v124, v[120:123] offset:8192
    ds_write_b128 v124, v[120:123] offset:9216
    ds_write_b128 v124, v[120:123] offset:10240
    ds_write_b128 v124, v[120:123] offset:11264
    ds_write_b128 v124, v[120:123] offset:12288
    ds_write_b128 v124, v[120:123] offset:13312
    ds_write_b128 v124, v[120:123] offset:14336
    ds_write_b128 v124, v[120:123] offset:15360
    ds_write_b128 v124, v[120:123] offset:16384
    s_setpc_b64 s[54:55]
K_ZERO:
    v_mov_b64 v[96:97], 0
    v_mov_b64 v[98:99], 0
    v_lshlrev_b32 v100, 4, v254
    v_add_u32 v100, 53632, v100
    ds_write_b128 v100, v[96:99] offset:0
    ds_write_b128 v100, v[96:99] offset:8192
    ds_write_b128 v100, v[96:99] offset:16384
    ds_write_b128 v100, v[96:99] offset:24576
    ds_write_b128 v100, v[96:99] offset:32768
    ds_write_b128 v100, v[96:99] offset:40960
    ds_write_b128 v100, v[96:99] offset:49152
    s_movk_i32 s3, 10
    v_cmp_gt_u32 vcc, s3, v254
    s_and_saveexec_b64 s[82:83], vcc
    ds_write_b128 v100, v[96:99] offset:57344
    s_mov_b64 exec, -1
    s_waitcnt lgkmcnt(0)
    s_barrier
    s_setpc_b64 s[54:55]
K_LOADS2:
    s_lshl_b32 s84, s25, 10
    s_add_u32 m0, s84, 129408
    s_add_u32 s3, s84, 0
    buffer_load_dwordx4 v236, s[20:23], s3 offen lds
    buffer_load_dwordx4 v[170:173], v237, s[4:7], s3 offen
    s_add_u32 m0, s84, 137600
    s_add_u32 s3, s84, 8192
    buffer_load_dwordx4 v236, s[20:23], s3 offen lds
    buffer_load_dwordx4 v[174:177], v237, s[4:7], s3 offen
    s_add_u32 m0, s84, 145792
    s_add_u32 s3, s84, 16384
    buffer_load_dwordx4 v236, s[20:23], s3 offen lds
    buffer_load_dwordx4 v[178:181], v237, s[4:7], s3 offen
    s_add_u32 m0, s84, 153984
    s_add_u32 s3, s84, 24576
    buffer_load_dwordx4 v236, s[20:23], s3 offen lds
    buffer_load_dwordx4 v[182:185], v237, s[4:7], s3 offen
    s_setpc_b64 s[54:55]
K_A:
    ds_read_b64_tr_b16 v[32:33], v244 offset:0
    ds_read_b64_tr_b16 v[34:35], v244 offset:1024
    ds_read_b64_tr_b16 v[36:37], v244 offset:8
    ds_read_b64_tr_b16 v[38:39], v244 offset:1032
    ds_read_b64_tr_b16 v[40:41], v244 offset:4096
    ds_read_b64_tr_b16 v[42:43], v244 offset:5120
    ds_read_b64_tr_b16 v[44:45], v244 offset:4104
    ds_read_b64_tr_b16 v[46:47], v244 offset:5128
    ds_read_b64_tr_b16 v[48:49], v244 offset:8192
    ds_read_b64_tr_b16 v[50:51], v244 offset:9216
    ds_read_b64_tr_b16 v[52:53], v244 offset:8200
    ds_read_b64_tr_b16 v[54:55], v244 offset:9224
    s_waitcnt lgkmcnt(8)
    v_mfma_f32_32x32x16_bf16 v[96:111], v[0:3], v[32:35], 0
    v_mfma_f32_32x32x16_bf16 v[112:127], v[0:3], v[36:39], 0
    ds_read_b64_tr_b16 v[56:57], v244 offset:12288
    ds_read_b64_tr_b16 v[58:59], v244 offset:13312
    ds_read_b64_tr_b16 v[60:61], v244 offset:12296
    ds_read_b64_tr_b16 v[62:63], v244 offset:13320
    s_waitcnt lgkmcnt(8)
    v_mfma_f32_32x32x16_bf16 v[96:111], v[4:7], v[40:43], v[96:111]
    v_mfma_f32_32x32x16_bf16 v[112:127], v[4:7], v[44:47], v[112:127]
    ds_read_b64_tr_b16 v[32:33], v244 offset:16384
    ds_read_b64_tr_b16 v[34:35], v244 offset:17408
    ds_read_b64_tr_b16 v[36:37], v244 offset:16392
    ds_read_b64_tr_b16 v[38:39], v244 offset:17416
    s_waitcnt lgkmcnt(8)
    v_mfma_f32_32x32x16_bf16 v[96:111], v[8:11], v[48:51], v[96:111]
    v_mfma_f32_32x32x16_bf16 v[112:127], v[8:11], v[52:55], v[112:127]
    ds_read_b64_tr_b16 v[40:41], v244 offset:20480
    ds_read_b64_tr_b16 v[42:43], v244 offset:21504
    ds_read_b64_tr_b16 v[44:45], v244 offset:20488
    ds_read_b64_tr_b16 v[46:47], v244 offset:21512
    s_waitcnt lgkmcnt(8)
    v_mfma_f32_32x32x16_bf16 v[96:111], v[12:15], v[56:59], v[96:111]
    v_mfma_f32_32x32x16_bf16 v[112:127], v[12:15], v[60:63], v[112:127]
    ds_read_b64_tr_b16 v[48:49], v244 offset:24576
    ds_read_b64_tr_b16 v[50:51], v244 offset:25600
    ds_read_b64_tr_b16 v[52:53], v244 offset:24584
    ds_read_b64_tr_b16 v[54:55], v244 offset:25608
    s_waitcnt lgkmcnt(8)
    v_mfma_f32_32x32x16_bf16 v[96:111], v[16:19], v[32:35], v[96:111]
    v_mfma_f32_32x32x16_bf16 v[112:127], v[16:19], v[36:39], v[112:127]
    ds_read_b64_tr_b16 v[56:57], v244 offset:28672
    ds_read_b64_tr_b16 v[58:59], v244 offset:29696
    ds_read_b64_tr_b16 v[60:61], v244 offset:28680
    ds_read_b64_tr_b16 v[62:63], v244 offset:29704
    s_waitcnt lgkmcnt(8)
    v_mfma_f32_32x32x16_bf16 v[96:111], v[20:23], v[40:43], v[96:111]
    v_mfma_f32_32x32x16_bf16 v[112:127], v[20:23], v[44:47], v[112:127]
    s_waitcnt lgkmcnt(4)
    v_mfma_f32_32x32x16_bf16 v[96:111], v[24:27], v[48:51], v[96:111]
    v_mfma_f32_32x32x16_bf16 v[112:127], v[24:27], v[52:55], v[112:127]
    s_waitcnt lgkmcnt(0)
    v_mfma_f32_32x32x16_bf16 v[96:111], v[28:31], v[56:59], v[96:111]
    v_mfma_f32_32x32x16_bf16 v[112:127], v[28:31], v[60:63], v[112:127]
    s_setpc_b64 s[54:55]
K_C:
    v_add_u32 v242, 79232, v242
    v_add_u32 v243, 79232, v243
    ds_read_b64_tr_b16 v[32:33], v242 offset:0
    ds_read_b64_tr_b16 v[34:35], v242 offset:1024
    ds_read_b64_tr_b16 v[36:37], v243 offset:0
    ds_read_b64_tr_b16 v[38:39], v243 offset:1024
    ds_read_b64_tr_b16 v[40:41], v242 offset:4096
    ds_read_b64_tr_b16 v[42:43], v242 offset:5120
    ds_read_b64_tr_b16 v[44:45], v243 offset:4096
    ds_read_b64_tr_b16 v[46:47], v243 offset:5120
    ds_read_b64_tr_b16 v[48:49], v242 offset:8192
    ds_read_b64_tr_b16 v[50:51], v242 offset:9216
    ds_read_b64_tr_b16 v[52:53], v243 offset:8192
    ds_read_b64_tr_b16 v[54:55], v243 offset:9216
    s_nop 3
    s_cmp_lt_u32 s25, 4
    s_cselect_b64 s[84:85], -1, 0
    v_mul_f32 v234, s80, v96
    v_mul_f32 v235, s80, v112
    ds_write_b64 v246, v[234:235] offset:1888
    v_mul_f32 v236, s80, v97
    v_mul_f32 v237, s80, v113
    ds_write_b64 v246, v[236:237] offset:2416
    s_waitcnt lgkmcnt(2)
    v_mfma_f32_32x32x16_bf16 v[64:79], v[0:3], v[32:35], 0
    v_mfma_f32_32x32x16_bf16 v[80:95], v[0:3], v[36:39], 0
    v_mfma_f32_32x32x16_bf16 v[64:79], v[4:7], v[40:43], v[64:79]
    v_mfma_f32_32x32x16_bf16 v[80:95], v[4:7], v[44:47], v[80:95]
    ds_read_b64_tr_b16 v[56:57], v242 offset:12288
    ds_read_b64_tr_b16 v[58:59], v242 offset:13312
    ds_read_b64_tr_b16 v[60:61], v243 offset:12288
    ds_read_b64_tr_b16 v[62:63], v243 offset:13312
    v_mul_f32 v234, s80, v98
    v_mul_f32 v235, s80, v114
    ds_write_b64 v246, v[234:235] offset:2944
    v_mul_f32 v236, s80, v99
    v_mul_f32 v237, s80, v115
    ds_write_b64 v246, v[236:237] offset:3472
    v_mul_f32 v234, s80, v100
    v_mul_f32 v235, s80, v116
    ds_write_b64 v246, v[234:235] offset:6112
    s_mov_b64 exec, -1
    s_waitcnt lgkmcnt(7)
    v_mfma_f32_32x32x16_bf16 v[64:79], v[8:11], v[48:51], v[64:79]
    v_mfma_f32_32x32x16_bf16 v[80:95], v[8:11], v[52:55], v[80:95]
    ds_read_b64_tr_b16 v[32:33], v242 offset:16384
    ds_read_b64_tr_b16 v[34:35], v242 offset:17408
    ds_read_b64_tr_b16 v[36:37], v243 offset:16384
    ds_read_b64_tr_b16 v[38:39], v243 offset:17408
    v_mul_f32 v236, s80, v101
    v_mul_f32 v237, s80, v117
    ds_write_b64 v246, v[236:237] offset:6640
    v_mul_f32 v234, s80, v102
    v_mul_f32 v235, s80, v118
    ds_write_b64 v246, v[234:235] offset:7168
    v_mul_f32 v236, s80, v103
    v_mul_f32 v237, s80, v119
    ds_write_b64 v246, v[236:237] offset:7696
    s_mov_b64 exec, -1
    s_waitcnt lgkmcnt(7)
    v_mfma_f32_32x32x16_bf16 v[64:79], v[12:15], v[56:59], v[64:79]
    v_mfma_f32_32x32x16_bf16 v[80:95], v[12:15], v[60:63], v[80:95]
    ds_read_b64_tr_b16 v[40:41], v242 offset:20480
    ds_read_b64_tr_b16 v[42:43], v242 offset:21504
    ds_read_b64_tr_b16 v[44:45], v243 offset:20480
    ds_read_b64_tr_b16 v[46:47], v243 offset:21504
    s_mov_b32 exec_hi, s84
    v_mul_f32 v234, s80, v104
    v_mul_f32 v235, s80, v120
    ds_write_b64 v246, v[234:235] offset:10336
    s_mov_b64 exec, s[84:85]
    v_mul_f32 v236, s80, v105
    v_mul_f32 v237, s80, v121
    ds_write_b64 v246, v[236:237] offset:10864
    v_mul_f32 v234, s80, v106
    v_mul_f32 v235, s80, v122
    ds_write_b64 v246, v[234:235] offset:11392
    s_mov_b64 exec, -1
    s_waitcnt lgkmcnt(7)
    v_mfma_f32_32x32x16_bf16 v[64:79], v[16:19], v[32:35], v[64:79]
    v_mfma_f32_32x32x16_bf16 v[80:95], v[16:19], v[36:39], v[80:95]
    ds_read_b64_tr_b16 v[48:49], v242 offset:24576
    ds_read_b64_tr_b16 v[50:51], v242 offset:25600
    ds_read_b64_tr_b16 v[52:53], v243 offset:24576
    ds_read_b64_tr_b16 v[54:55], v243 offset:25600
    s_mov_b64 exec, s[84:85]
    v_mul_f32 v236, s80, v107
    v_mul_f32 v237, s80, v123
    ds_write_b64 v246, v[236:237] offset:11920
    v_mul_f32 v234, s80, v108
    v_mul_f32 v235, s80, v124
    ds_write_b64 v246, v[234:235] offset:14560
    v_mul_f32 v236, s80, v109
    v_mul_f32 v237, s80, v125
    ds_write_b64 v246, v[236:237] offset:15088
    s_mov_b64 exec, -1
    s_waitcnt lgkmcnt(7)
    v_mfma_f32_32x32x16_bf16 v[64:79], v[20:23], v[40:43], v[64:79]
    v_mfma_f32_32x32x16_bf16 v[80:95], v[20:23], v[44:47], v[80:95]
    ds_read_b64_tr_b16 v[56:57], v242 offset:28672
    ds_read_b64_tr_b16 v[58:59], v242 offset:29696
    ds_read_b64_tr_b16 v[60:61], v243 offset:28672
    ds_read_b64_tr_b16 v[62:63], v243 offset:29696
    s_mov_b64 exec, s[84:85]
    v_mul_f32 v234, s80, v110
    v_mul_f32 v235, s80, v126
    ds_write_b64 v246, v[234:235] offset:15616
    v_mul_f32 v236, s80, v111
    v_mul_f32 v237, s80, v127
    ds_write_b64 v246, v[236:237] offset:16144
    s_mov_b64 exec, -1
    s_waitcnt lgkmcnt(6)
    v_mfma_f32_32x32x16_bf16 v[64:79], v[24:27], v[48:51], v[64:79]
    v_mfma_f32_32x32x16_bf16 v[80:95], v[24:27], v[52:55], v[80:95]
    s_waitcnt lgkmcnt(0)
    v_mfma_f32_32x32x16_bf16 v[64:79], v[28:31], v[56:59], v[64:79]
    v_mfma_f32_32x32x16_bf16 v[80:95], v[28:31], v[60:63], v[80:95]
    s_setpc_b64 s[54:55]
K2_EVENT:
    s_setprio 0
    s_sub_u32 s3, s32, 7
    s_cmp_gt_i32 s31, s3
    s_cbranch_scc1 K2_EV1
    s_mov_b32 s52, s3
    s_setpc_b64 s[54:55]
K2_EV1:
    s_sub_u32 s52, s32, 1
    v_and_b32 v251, 31, v250
    v_lshlrev_b32 v251, 7, v251
    s_lshl_b32 s3, s25, 12
    s_mov_b64 exec, 0xffffffff
    buffer_load_dword v251, v251, s[44:47], s3 offen
    buffer_load_dword v251, v251, s[16:19], s3 offen
    s_mov_b64 exec, -1
    s_setpc_b64 s[54:55]
K2_EDGE:
    s_mov_b32 s97, s34
    s_call_b64 s[54:55], K2_FLUSH
    s_cmp_eq_u32 s97, s31
    s_cbranch_scc1 K2_EDGE1
    v_mov_b64 v[192:193], 0
    v_mov_b64 v[194:195], v[252:253]
    s_nop 1
    v_mfma_f32_32x32x16_bf16 v[0:15], v[192:195], v[144:147], v[0:15]
    v_mfma_f32_32x32x16_bf16 v[16:31], v[192:195], v[148:151], v[16:31]
    v_mfma_f32_32x32x16_bf16 v[32:47], v[192:195], v[152:155], v[32:47]
    v_mfma_f32_32x32x16_bf16 v[48:63], v[192:195], v[156:159], v[48:63]
    s_cmp_eq_u32 s31, s34
    s_cbranch_scc0 K2_EDGE1
    s_cmp_lt_u32 s31, s32
    s_cbranch_scc0 K2_EDGE1
    s_nop 7
    s_branch K2_EDGE
K2_EDGE1:
    s_setpc_b64 s[98:99]
K2_FLUSH:
    s_mul_i32 s3, s33, 4224
    v_add_u32 v140, s3, v231
    s_lshl_b32 s3, s33, 7
    v_add_u32 v141, s3, v232
    s_mov_b32 s48, s33
    v_mul_f32 v128, v212, v1
    v_mul_f32 v129, v212, v5
    v_mul_f32 v130, v212, v9
    v_mul_f32 v131, v212, v13
    v_pk_mul_f32 v[132:133], v[2:3], v[212:213] op_sel_hi:[1,0]
    v_pk_mul_f32 v[134:135], v[6:7], v[212:213] op_sel_hi:[1,0]
    v_pk_mul_f32 v[136:137], v[10:11], v[212:213] op_sel_hi:[1,0]
    v_pk_mul_f32 v[138:139], v[14:15], v[212:213] op_sel_hi:[1,0]
    v_fmac_f32 v128, v213, v17
    v_fmac_f32 v129, v213, v21
    v_fmac_f32 v130, v213, v25
    v_fmac_f32 v131, v213, v29
    v_mov_b32 v142, v213
    v_pk_fma_f32 v[132:133], v[18:19], v[142:143], v[132:133] op_sel_hi:[1,0,1]
    v_pk_fma_f32 v[134:135], v[22:23], v[142:143], v[134:135] op_sel_hi:[1,0,1]
    v_pk_fma_f32 v[136:137], v[26:27], v[142:143], v[136:137] op_sel_hi:[1,0,1]
    v_pk_fma_f32 v[138:139], v[30:31], v[142:143], v[138:139] op_sel_hi:[1,0,1]
    v_fmac_f32 v128, v214, v33
    v_fmac_f32 v129, v214, v37
    v_fmac_f32 v130, v214, v41
    v_fmac_f32 v131, v214, v45
    v_pk_fma_f32 v[132:133], v[34:35], v[214:215], v[132:133] op_sel_hi:[1,0,1]
    v_pk_fma_f32 v[134:135], v[38:39], v[214:215], v[134:135] op_sel_hi:[1,0,1]
    v_pk_fma_f32 v[136:137], v[42:43], v[214:215], v[136:137] op_sel_hi:[1,0,1]
    v_pk_fma_f32 v[138:139], v[46:47], v[214:215], v[138:139] op_sel_hi:[1,0,1]
    v_fmac_f32 v128, v215, v49
    v_fmac_f32 v129, v215, v53
    v_fmac_f32 v130, v215, v57
    v_fmac_f32 v131, v215, v61
    v_mov_b32 v142, v215
    v_pk_fma_f32 v[132:133], v[50:51], v[142:143], v[132:133] op_sel_hi:[1,0,1]
    v_pk_fma_f32 v[134:135], v[54:55], v[142:143], v[134:135] op_sel_hi:[1,0,1]
    v_pk_fma_f32 v[136:137], v[58:59], v[142:143], v[136:137] op_sel_hi:[1,0,1]
    v_pk_fma_f32 v[138:139], v[62:63], v[142:143], v[138:139] op_sel_hi:[1,0,1]
    v_cmp_ge_u32 vcc, s97, v233
    v_permlane16_swap_b32 v128, v129
    v_permlane16_swap_b32 v132, v134
    v_permlane16_swap_b32 v133, v135
    v_permlane16_swap_b32 v130, v131
    v_permlane16_swap_b32 v136, v138
    v_permlane16_swap_b32 v137, v139
    s_and_b64 vcc, vcc, s[62:63]
    s_bcnt1_i32_b64 s33, vcc
    s_lshl_b32 s3, s33, 2
    v_add_f32 v128, v128, v129
    v_add_f32 v132, v132, v134
    v_add_f32 v133, v133, v135
    v_add_f32 v130, v130, v131
    v_add_f32 v136, v136, v138
    v_add_f32 v137, v137, v139
    v_readlane_b32 s34, v233, s3
    v_add_f32_dpp v129, v128, v128 row_ror:8 row_mask:0xf bank_mask:0x3
    v_add_f32_dpp v134, v132, v132 row_ror:8 row_mask:0xf bank_mask:0x3
    v_add_f32_dpp v135, v133, v133 row_ror:8 row_mask:0xf bank_mask:0x3
    v_add_f32_dpp v129, v130, v130 row_ror:8 row_mask:0xf bank_mask:0xc
    v_add_f32_dpp v134, v136, v136 row_ror:8 row_mask:0xf bank_mask:0xc
    v_add_f32_dpp v135, v137, v137 row_ror:8 row_mask:0xf bank_mask:0xc
    v_add_f32_dpp v142, v129, v129 row_half_mirror row_mask:0xf bank_mask:0x5
    s_nop 0
    v_add_f32_dpp v143, v135, v135 row_half_mirror row_mask:0xf bank_mask:0xf
    v_add_f32_dpp v142, v134, v134 row_half_mirror row_mask:0xf bank_mask:0xa
    s_cmp_eq_u32 s49, 2
    v_add_f32_dpp v143, v143, v143 quad_perm:[1,0,3,2] row_mask:0xf bank_mask:0xf
    v_add_f32_dpp v142, v142, v142 quad_perm:[1,0,3,2] row_mask:0xf bank_mask:0xf
    s_nop 0
    v_add_f32_dpp v143, v143, v143 quad_perm:[2,3,0,1] row_mask:0xf bank_mask:0xf
    v_add_f32_dpp v142, v142, v142 quad_perm:[2,3,0,1] row_mask:0xf bank_mask:0xf
    s_cbranch_scc1 K2_FLRET
    s_cmp_eq_u32 s49, 0
    s_cbranch_scc1 K2_FLW
K2_FLUSH2:
    ds_read_b32 v136, v141
    ds_read_b32 v137, v141 offset:8
    ds_read_b32 v128, v140 offset:0
    ds_read_b32 v129, v140 offset:128
    ds_read_b32 v130, v140 offset:256
    ds_read_b32 v131, v140 offset:384
    ds_read_b32 v132, v140 offset:1056
    ds_read_b32 v133, v140 offset:1184
    ds_read_b32 v134, v140 offset:1312
    ds_read_b32 v135, v140 offset:1440
    s_waitcnt lgkmcnt(0)
    v_add_f32 v0, v0, v128
    v_add_f32 v16, v16, v129
    v_add_f32 v32, v32, v130
    v_add_f32 v48, v48, v131
    v_add_f32 v4, v4, v132
    v_add_f32 v20, v20, v133
    v_add_f32 v36, v36, v134
    v_add_f32 v52, v52, v135
    ds_read_b32 v128, v140 offset:2112
    ds_read_b32 v129, v140 offset:2240
    ds_read_b32 v130, v140 offset:2368
    ds_read_b32 v131, v140 offset:2496
    ds_read_b32 v132, v140 offset:3168
    ds_read_b32 v133, v140 offset:3296
    ds_read_b32 v134, v140 offset:3424
    ds_read_b32 v135, v140 offset:3552
    s_waitcnt lgkmcnt(0)
    v_add_f32 v8, v8, v128
    v_add_f32 v24, v24, v129
    v_add_f32 v40, v40, v130
    v_add_f32 v56, v56, v131
    v_add_f32 v12, v12, v132
    v_add_f32 v28, v28, v133
    v_add_f32 v44, v44, v134
    v_add_f32 v60, v60, v135
    v_add_f32 v142, v142, v136
    v_add_f32 v143, v143, v137
K2_FLW:
    v_mov_b64 v[136:137], 0
    v_mov_b64 v[138:139], 0
    ds_write_b32 v141, v142
    ds_write_b32 v141, v143 offset:8
    ds_write_b32 v140, v0 offset:0
    ds_write_b32 v140, v16 offset:128
    ds_write_b32 v140, v32 offset:256
    ds_write_b32 v140, v48 offset:384
    s_cmp_eq_u32 s48, 12
    s_cbranch_scc1 K2_FL1
    ds_write_b32 v140, v4 offset:1056
    ds_write_b32 v140, v20 offset:1184
    ds_write_b32 v140, v36 offset:1312
    ds_write_b32 v140, v52 offset:1440
    ds_write_b32 v140, v8 offset:2112
    ds_write_b32 v140, v24 offset:2240
    ds_write_b32 v140, v40 offset:2368
    ds_write_b32 v140, v56 offset:2496
    ds_write_b32 v140, v12 offset:3168
    ds_write_b32 v140, v28 offset:3296
    ds_write_b32 v140, v44 offset:3424
    ds_write_b32 v140, v60 offset:3552
K2_FL1:
    s_cmp_eq_u32 s49, 2
    s_waitcnt lgkmcnt(0)
    s_cbranch_scc1 K2_FLRET
    s_lshl_b32 s3, s48, 2
    v_mov_b32 v128, s3
    v_mov_b32 v129, 1
    ds_write_b32 v128, v129 offset:260
    v_mfma_f32_32x32x16_bf16 v[0:15], v[136:139], v[136:139], 0
    v_mfma_f32_32x32x16_bf16 v[16:31], v[136:139], v[136:139], 0
    v_mfma_f32_32x32x16_bf16 v[32:47], v[136:139], v[136:139], 0
    v_mfma_f32_32x32x16_bf16 v[48:63], v[136:139], v[136:139], 0
K2_FLRET:
    s_setpc_b64 s[54:55]
K2_EPI:
    s_mov_b32 s50, 0
K2_FAST:
    s_cmp_eq_u32 s50, 0
    s_cbranch_scc1 K2_F2
    ds_read_b32 v128, v141
    ds_read_b32 v129, v141 offset:8
    ds_read_b32 v144, v140 offset:0
    ds_read_b32 v145, v140 offset:128
    ds_read_b32 v146, v140 offset:256
    ds_read_b32 v147, v140 offset:384
    ds_read_b32 v148, v140 offset:1056
    ds_read_b32 v149, v140 offset:1184
    ds_read_b32 v150, v140 offset:1312
    ds_read_b32 v151, v140 offset:1440
    ds_read_b32 v152, v140 offset:2112
    ds_read_b32 v153, v140 offset:2240
    ds_read_b32 v154, v140 offset:2368
    ds_read_b32 v155, v140 offset:2496
    ds_read_b32 v156, v140 offset:3168
    ds_read_b32 v157, v140 offset:3296
    ds_read_b32 v158, v140 offset:3424
    ds_read_b32 v159, v140 offset:3552
    s_waitcnt lgkmcnt(12)
    v_add_f32 v142, v142, v128
    v_add_f32 v143, v143, v129
    ds_write_b32 v141, v142
    ds_write_b32 v141, v143 offset:8
    s_cmp_eq_u32 s48, 12
    v_add_f32 v0, v0, v144
    ds_write_b32 v140, v0 offset:0
    v_add_f32 v16, v16, v145
    ds_write_b32 v140, v16 offset:128
    v_add_f32 v32, v32, v146
    ds_write_b32 v140, v32 offset:256
    v_add_f32 v48, v48, v147
    ds_write_b32 v140, v48 offset:384
    s_cbranch_scc1 K2_F2
    s_waitcnt lgkmcnt(14)
    v_add_f32 v4, v4, v148
    ds_write_b32 v140, v4 offset:1056
    v_add_f32 v20, v20, v149
    ds_write_b32 v140, v20 offset:1184
    v_add_f32 v36, v36, v150
    ds_write_b32 v140, v36 offset:1312
    v_add_f32 v52, v52, v151
    ds_write_b32 v140, v52 offset:1440
    s_waitcnt lgkmcnt(14)
    v_add_f32 v8, v8, v152
    ds_write_b32 v140, v8 offset:2112
    v_add_f32 v24, v24, v153
    ds_write_b32 v140, v24 offset:2240
    v_add_f32 v40, v40, v154
    ds_write_b32 v140, v40 offset:2368
    v_add_f32 v56, v56, v155
    ds_write_b32 v140, v56 offset:2496
    s_waitcnt lgkmcnt(14)
    v_add_f32 v12, v12, v156
    ds_write_b32 v140, v12 offset:3168
    v_add_f32 v28, v28, v157
    ds_write_b32 v140, v28 offset:3296
    v_add_f32 v44, v44, v158
    ds_write_b32 v140, v44 offset:3424
    v_add_f32 v60, v60, v159
    ds_write_b32 v140, v60 offset:3552
K2_F2:
K2_F3:
    s_waitcnt lgkmcnt(0)
    s_barrier
    ds_read_b128 v[0:3], v252 offset:53632
    ds_read_b128 v[4:7], v252 offset:53648
    ds_read_b64_tr_b16 v[32:33], v251 offset:0
    ds_read_b64_tr_b16 v[34:35], v251 offset:4096
    ds_read_b64_tr_b16 v[36:37], v253 offset:0
    ds_read_b64_tr_b16 v[38:39], v253 offset:4096
    s_waitcnt vmcnt(0)
    v_lshlrev_b32 v160, 16, v192
    v_and_b32 v176, 0xffff0000, v192
    v_lshlrev_b32 v161, 16, v193
    v_and_b32 v177, 0xffff0000, v193
    ds_read_b128 v[8:11], v252 offset:53696
    ds_read_b128 v[12:15], v252 offset:53712
    ds_read_b64_tr_b16 v[40:41], v251 offset:16384
    ds_read_b64_tr_b16 v[42:43], v251 offset:20480
    ds_read_b64_tr_b16 v[44:45], v253 offset:16384
    ds_read_b64_tr_b16 v[46:47], v253 offset:20480
    v_lshlrev_b32 v162, 16, v194
    v_and_b32 v178, 0xffff0000, v194
    v_lshlrev_b32 v163, 16, v195
    v_and_b32 v179, 0xffff0000, v195
    s_waitcnt lgkmcnt(6)
    v_cvt_pk_bf16_f32 v96, v0, v1
    v_cvt_pk_bf16_f32 v97, v2, v3
    v_cvt_pk_bf16_f32 v98, v4, v5
    v_cvt_pk_bf16_f32 v99, v6, v7
    s_nop 1
    v_mfma_f32_32x32x16_bf16 v[64:79], v[96:99], v[32:35], v[64:79]
    v_mfma_f32_32x32x16_bf16 v[80:95], v[96:99], v[36:39], v[80:95]
    ds_read_b128 v[16:19], v252 offset:53760
    ds_read_b128 v[20:23], v252 offset:53776
    ds_read_b64_tr_b16 v[48:49], v251 offset:1024
    ds_read_b64_tr_b16 v[50:51], v251 offset:5120
    ds_read_b64_tr_b16 v[52:53], v253 offset:1024
    ds_read_b64_tr_b16 v[54:55], v253 offset:5120
    v_lshlrev_b32 v164, 16, v196
    v_and_b32 v180, 0xffff0000, v196
    v_lshlrev_b32 v165, 16, v197
    v_and_b32 v181, 0xffff0000, v197
    s_waitcnt lgkmcnt(6)
    v_cvt_pk_bf16_f32 v100, v8, v9
    v_cvt_pk_bf16_f32 v101, v10, v11
    v_cvt_pk_bf16_f32 v102, v12, v13
    v_cvt_pk_bf16_f32 v103, v14, v15
    s_nop 1
    v_mfma_f32_32x32x16_bf16 v[64:79], v[100:103], v[40:43], v[64:79]
    v_mfma_f32_32x32x16_bf16 v[80:95], v[100:103], v[44:47], v[80:95]
    ds_read_b128 v[24:27], v252 offset:53824
    ds_read_b128 v[28:31], v252 offset:53840
    ds_read_b64_tr_b16 v[56:57], v251 offset:17408
    ds_read_b64_tr_b16 v[58:59], v251 offset:21504
    ds_read_b64_tr_b16 v[60:61], v253 offset:17408
    ds_read_b64_tr_b16 v[62:63], v253 offset:21504
    v_lshlrev_b32 v166, 16, v198
    v_and_b32 v182, 0xffff0000, v198
    v_lshlrev_b32 v167, 16, v199
    v_and_b32 v183, 0xffff0000, v199
    s_waitcnt lgkmcnt(6)
    v_cvt_pk_bf16_f32 v104, v16, v17
    v_cvt_pk_bf16_f32 v105, v18, v19
    v_cvt_pk_bf16_f32 v106, v20, v21
    v_cvt_pk_bf16_f32 v107, v22, v23
    s_nop 1
    v_mfma_f32_32x32x16_bf16 v[64:79], v[104:107], v[48:51], v[64:79]
    v_mfma_f32_32x32x16_bf16 v[80:95], v[104:107], v[52:55], v[80:95]
    ds_read_b128 v[0:3], v252 offset:53888
    ds_read_b128 v[4:7], v252 offset:53904
    ds_read_b64_tr_b16 v[32:33], v251 offset:2048
    ds_read_b64_tr_b16 v[34:35], v251 offset:6144
    ds_read_b64_tr_b16 v[36:37], v253 offset:2048
    ds_read_b64_tr_b16 v[38:39], v253 offset:6144
    v_lshlrev_b32 v168, 16, v200
    v_and_b32 v184, 0xffff0000, v200
    v_lshlrev_b32 v169, 16, v201
    v_and_b32 v185, 0xffff0000, v201
    s_waitcnt lgkmcnt(6)
    v_cvt_pk_bf16_f32 v108, v24, v25
    v_cvt_pk_bf16_f32 v109, v26, v27
    v_cvt_pk_bf16_f32 v110, v28, v29
    v_cvt_pk_bf16_f32 v111, v30, v31
    s_nop 1
    v_mfma_f32_32x32x16_bf16 v[64:79], v[108:111], v[56:59], v[64:79]
    v_mfma_f32_32x32x16_bf16 v[80:95], v[108:111], v[60:63], v[80:95]
    ds_read_b128 v[8:11], v252 offset:53952
    ds_read_b128 v[12:15], v252 offset:53968
    ds_read_b64_tr_b16 v[40:41], v251 offset:18432
    ds_read_b64_tr_b16 v[42:43], v251 offset:22528
    ds_read_b64_tr_b16 v[44:45], v253 offset:18432
    ds_read_b64_tr_b16 v[46:47], v253 offset:22528
    v_lshlrev_b32 v170, 16, v202
    v_and_b32 v186, 0xffff0000, v202
    v_lshlrev_b32 v171, 16, v203
    v_and_b32 v187, 0xffff0000, v203
    s_waitcnt lgkmcnt(6)
    v_cvt_pk_bf16_f32 v96, v0, v1
    v_cvt_pk_bf16_f32 v97, v2, v3
    v_cvt_pk_bf16_f32 v98, v4, v5
    v_cvt_pk_bf16_f32 v99, v6, v7
    s_nop 1
    v_mfma_f32_32x32x16_bf16 v[64:79], v[96:99], v[32:35], v[64:79]
    v_mfma_f32_32x32x16_bf16 v[80:95], v[96:99], v[36:39], v[80:95]
    ds_read_b128 v[16:19], v252 offset:54016
    ds_read_b128 v[20:23], v252 offset:54032
    ds_read_b64_tr_b16 v[48:49], v251 offset:3072
    ds_read_b64_tr_b16 v[50:51], v251 offset:7168
    ds_read_b64_tr_b16 v[52:53], v253 offset:3072
    ds_read_b64_tr_b16 v[54:55], v253 offset:7168
    v_lshlrev_b32 v172, 16, v204
    v_and_b32 v188, 0xffff0000, v204
    v_lshlrev_b32 v173, 16, v205
    v_and_b32 v189, 0xffff0000, v205
    s_waitcnt lgkmcnt(6)
    v_cvt_pk_bf16_f32 v100, v8, v9
    v_cvt_pk_bf16_f32 v101, v10, v11
    v_cvt_pk_bf16_f32 v102, v12, v13
    v_cvt_pk_bf16_f32 v103, v14, v15
    s_nop 1
    v_mfma_f32_32x32x16_bf16 v[64:79], v[100:103], v[40:43], v[64:79]
    v_mfma_f32_32x32x16_bf16 v[80:95], v[100:103], v[44:47], v[80:95]
    ds_read_b128 v[24:27], v252 offset:54080
    ds_read_b128 v[28:31], v252 offset:54096
    ds_read_b64_tr_b16 v[56:57], v251 offset:19456
    ds_read_b64_tr_b16 v[58:59], v251 offset:23552
    ds_read_b64_tr_b16 v[60:61], v253 offset:19456
    ds_read_b64_tr_b16 v[62:63], v253 offset:23552
    v_lshlrev_b32 v174, 16, v206
    v_and_b32 v190, 0xffff0000, v206
    v_lshlrev_b32 v175, 16, v207
    v_and_b32 v191, 0xffff0000, v207
    s_waitcnt lgkmcnt(6)
    v_cvt_pk_bf16_f32 v104, v16, v17
    v_cvt_pk_bf16_f32 v105, v18, v19
    v_cvt_pk_bf16_f32 v106, v20, v21
    v_cvt_pk_bf16_f32 v107, v22, v23
    s_nop 1
    v_mfma_f32_32x32x16_bf16 v[64:79], v[104:107], v[48:51], v[64:79]
    v_mfma_f32_32x32x16_bf16 v[80:95], v[104:107], v[52:55], v[80:95]
    s_waitcnt lgkmcnt(0)
    v_cvt_pk_bf16_f32 v108, v24, v25
    v_cvt_pk_bf16_f32 v109, v26, v27
    v_cvt_pk_bf16_f32 v110, v28, v29
    v_cvt_pk_bf16_f32 v111, v30, v31
    s_nop 1
    v_mfma_f32_32x32x16_bf16 v[64:79], v[108:111], v[56:59], v[64:79]
    v_mfma_f32_32x32x16_bf16 v[80:95], v[108:111], v[60:63], v[80:95]
    s_cmp_eq_u32 s25, 7
    s_cbranch_scc0 K2_NOPOS
    s_mul_i32 s84, s86, 6
    s_add_u32 s84, s84, 6400000
    s_mul_i32 s85, s87, 6
    s_add_u32 s44, s36, s84
    s_addc_u32 s45, s37, 0
    s_mov_b32 s46, s85
    s_mov_b32 s47, 0x20000
    v_lshlrev_b32 v0, 4, v250
    v_add_u32 v1, 109472, v0
    ds_read_b128 v[4:7], v0 offset:320
    ds_read_b128 v[8:11], v1
    ds_read_b128 v[12:15], v0 offset:1344
    ds_read_b128 v[16:19], v1 offset:1024
    v_mul_u32_u24 v2, 6, v250
    v_add_u32 v2, 105376, v2
    v_add_u32 v3, 105376, v0
    s_waitcnt lgkmcnt(2)
    v_add_f32 v4, v4, v8
    v_add_f32 v5, v5, v9
    v_add_f32 v6, v6, v10
    v_cvt_pk_bf16_f32 v4, v4, v5
    v_cvt_pk_bf16_f32 v6, v6, v6
    ds_write_b16 v2, v4
    ds_write_b16_d16_hi v2, v4 offset:2
    ds_write_b16 v2, v6 offset:4
    s_waitcnt lgkmcnt(3)
    v_add_f32 v12, v12, v16
    v_add_f32 v13, v13, v17
    v_add_f32 v14, v14, v18
    v_cvt_pk_bf16_f32 v12, v12, v13
    v_cvt_pk_bf16_f32 v14, v14, v14
    ds_write_b16 v2, v12 offset:384
    ds_write_b16_d16_hi v2, v12 offset:386
    ds_write_b16 v2, v14 offset:388
    ds_read_b128 v[4:7], v3
    s_waitcnt lgkmcnt(0)
    buffer_store_dwordx4 v[4:7], v0, s[44:47], 0 offen sc1
    s_nop 1
K2_NOPOS:
    s_lshl_b32 s3, s25, 12
    v_lshl_add_u32 v253, v250, 4, s3
    v_lshrrev_b32 v251, 5, v250
    v_lshl_add_u32 v251, v251, 9, s3
    v_and_b32 v252, 31, v250
    v_lshl_add_u32 v251, v252, 2, v251
    v_lshrrev_b32 v252, 3, v250
    v_lshlrev_b32 v252, 8, v252
    v_and_b32 v219, 7, v250
    v_lshl_add_u32 v252, v219, 4, v252
    v_exp_f32 v0, v64
    v_exp_f32 v1, v65
    v_exp_f32 v2, v66
    v_exp_f32 v3, v67
    v_exp_f32 v16, v80
    v_exp_f32 v17, v81
    v_exp_f32 v18, v82
    v_exp_f32 v19, v83
    v_pk_add_f32 v[0:1], v[0:1], 1.0 op_sel_hi:[1,0]
    v_pk_add_f32 v[2:3], v[2:3], 1.0 op_sel_hi:[1,0]
    v_pk_add_f32 v[16:17], v[16:17], 1.0 op_sel_hi:[1,0]
    v_pk_add_f32 v[18:19], v[18:19], 1.0 op_sel_hi:[1,0]
    v_rcp_f32 v0, v0
    v_rcp_f32 v1, v1
    v_rcp_f32 v2, v2
    v_rcp_f32 v3, v3
    v_rcp_f32 v16, v16
    v_rcp_f32 v17, v17
    v_rcp_f32 v18, v18
    v_rcp_f32 v19, v19
    v_pk_mul_f32 v[0:1], v[0:1], v[64:65]
    v_pk_mul_f32 v[2:3], v[2:3], v[66:67]
    v_pk_mul_f32 v[16:17], v[16:17], v[80:81]
    v_pk_mul_f32 v[18:19], v[18:19], v[82:83]
    v_pk_fma_f32 v[0:1], v[0:1], s[80:81], v[160:161]
    v_pk_fma_f32 v[2:3], v[2:3], s[80:81], v[162:163]
    v_pk_fma_f32 v[16:17], v[16:17], s[80:81], v[176:177]
    v_pk_fma_f32 v[18:19], v[18:19], s[80:81], v[178:179]
    v_cvt_pk_bf16_f32 v32, v0, v16
    ds_write_b32 v251, v32 offset:1888
    v_cvt_pk_bf16_f32 v33, v1, v17
    ds_write_b32 v251, v33 offset:2016
    v_cvt_pk_bf16_f32 v34, v2, v18
    ds_write_b32 v251, v34 offset:2144
    v_cvt_pk_bf16_f32 v35, v3, v19
    ds_write_b32 v251, v35 offset:2272
    ds_read_b128 v[48:51], v253 offset:1888
    v_exp_f32 v4, v68
    v_exp_f32 v5, v69
    v_exp_f32 v6, v70
    v_exp_f32 v7, v71
    v_exp_f32 v20, v84
    v_exp_f32 v21, v85
    v_exp_f32 v22, v86
    v_exp_f32 v23, v87
    v_pk_add_f32 v[4:5], v[4:5], 1.0 op_sel_hi:[1,0]
    v_pk_add_f32 v[6:7], v[6:7], 1.0 op_sel_hi:[1,0]
    v_pk_add_f32 v[20:21], v[20:21], 1.0 op_sel_hi:[1,0]
    v_pk_add_f32 v[22:23], v[22:23], 1.0 op_sel_hi:[1,0]
    v_rcp_f32 v4, v4
    v_rcp_f32 v5, v5
    v_rcp_f32 v6, v6
    v_rcp_f32 v7, v7
    v_rcp_f32 v20, v20
    v_rcp_f32 v21, v21
    v_rcp_f32 v22, v22
    v_rcp_f32 v23, v23
    s_waitcnt lgkmcnt(0)
    buffer_store_dwordx4 v[48:51], v252, s[20:23], s58 offen offset:0 sc1
    v_pk_mul_f32 v[4:5], v[4:5], v[68:69]
    v_pk_mul_f32 v[6:7], v[6:7], v[70:71]
    v_pk_mul_f32 v[20:21], v[20:21], v[84:85]
    v_pk_mul_f32 v[22:23], v[22:23], v[86:87]
    v_pk_fma_f32 v[4:5], v[4:5], s[80:81], v[164:165]
    v_pk_fma_f32 v[6:7], v[6:7], s[80:81], v[166:167]
    v_pk_fma_f32 v[20:21], v[20:21], s[80:81], v[180:181]
    v_pk_fma_f32 v[22:23], v[22:23], s[80:81], v[182:183]
    v_cvt_pk_bf16_f32 v36, v4, v20
    ds_write_b32 v251, v36 offset:2912
    v_cvt_pk_bf16_f32 v37, v5, v21
    ds_write_b32 v251, v37 offset:3040
    v_cvt_pk_bf16_f32 v38, v6, v22
    ds_write_b32 v251, v38 offset:3168
    v_cvt_pk_bf16_f32 v39, v7, v23
    ds_write_b32 v251, v39 offset:3296
    ds_read_b128 v[52:55], v253 offset:2912
    s_cmp_lt_u32 s25, 4
    s_cbranch_scc1 K2_G1
    v_exp_f32 v8, v72
    v_exp_f32 v24, v88
    s_waitcnt lgkmcnt(0)
    buffer_store_dwordx4 v[52:55], v252, s[20:23], s58 offen offset:2048 sc1
    v_add_f32 v8, 1.0, v8
    v_add_f32 v24, 1.0, v24
    v_rcp_f32 v8, v8
    v_rcp_f32 v24, v24
    s_nop 0
    v_mul_f32 v8, v8, v72
    v_mul_f32 v24, v24, v88
    v_fma_f32 v8, v8, s80, v168
    v_fma_f32 v24, v24, s80, v184
    v_cvt_pk_bf16_f32 v40, v8, v24
    s_mov_b32 exec_hi, 0
    buffer_store_dword v40, v218, s[20:23], s59 offen sc1
    s_branch K2_G4
K2_G1:
    v_exp_f32 v8, v72
    v_exp_f32 v9, v73
    v_exp_f32 v10, v74
    v_exp_f32 v11, v75
    v_exp_f32 v24, v88
    v_exp_f32 v25, v89
    v_exp_f32 v26, v90
    v_exp_f32 v27, v91
    v_pk_add_f32 v[8:9], v[8:9], 1.0 op_sel_hi:[1,0]
    v_pk_add_f32 v[10:11], v[10:11], 1.0 op_sel_hi:[1,0]
    v_pk_add_f32 v[24:25], v[24:25], 1.0 op_sel_hi:[1,0]
    v_pk_add_f32 v[26:27], v[26:27], 1.0 op_sel_hi:[1,0]
    v_rcp_f32 v8, v8
    v_rcp_f32 v9, v9
    v_rcp_f32 v10, v10
    v_rcp_f32 v11, v11
    v_rcp_f32 v24, v24
    v_rcp_f32 v25, v25
    v_rcp_f32 v26, v26
    v_rcp_f32 v27, v27
    s_waitcnt lgkmcnt(0)
    buffer_store_dwordx4 v[52:55], v252, s[20:23], s58 offen offset:2048 sc1
    v_pk_mul_f32 v[8:9], v[8:9], v[72:73]
    v_pk_mul_f32 v[10:11], v[10:11], v[74:75]
    v_pk_mul_f32 v[24:25], v[24:25], v[88:89]
    v_pk_mul_f32 v[26:27], v[26:27], v[90:91]
    v_pk_fma_f32 v[8:9], v[8:9], s[80:81], v[168:169]
    v_pk_fma_f32 v[10:11], v[10:11], s[80:81], v[170:171]
    v_pk_fma_f32 v[24:25], v[24:25], s[80:81], v[184:185]
    v_pk_fma_f32 v[26:27], v[26:27], s[80:81], v[186:187]
    v_cvt_pk_bf16_f32 v40, v8, v24
    ds_write_b32 v251, v40 offset:3936
    v_cvt_pk_bf16_f32 v41, v9, v25
    ds_write_b32 v251, v41 offset:4064
    v_cvt_pk_bf16_f32 v42, v10, v26
    ds_write_b32 v251, v42 offset:4192
    v_cvt_pk_bf16_f32 v43, v11, v27
    ds_write_b32 v251, v43 offset:4320
    ds_read_b128 v[56:59], v253 offset:3936
    v_exp_f32 v12, v76
    v_exp_f32 v13, v77
    v_exp_f32 v14, v78
    v_exp_f32 v15, v79
    v_exp_f32 v28, v92
    v_exp_f32 v29, v93
    v_exp_f32 v30, v94
    v_exp_f32 v31, v95
    v_pk_add_f32 v[12:13], v[12:13], 1.0 op_sel_hi:[1,0]
    v_pk_add_f32 v[14:15], v[14:15], 1.0 op_sel_hi:[1,0]
    v_pk_add_f32 v[28:29], v[28:29], 1.0 op_sel_hi:[1,0]
    v_pk_add_f32 v[30:31], v[30:31], 1.0 op_sel_hi:[1,0]
    v_rcp_f32 v12, v12
    v_rcp_f32 v13, v13
    v_rcp_f32 v14, v14
    v_rcp_f32 v15, v15
    v_rcp_f32 v28, v28
    v_rcp_f32 v29, v29
    v_rcp_f32 v30, v30
    v_rcp_f32 v31, v31
    s_waitcnt lgkmcnt(0)
    buffer_store_dwordx4 v[56:59], v252, s[20:23], s59 offen offset:0 sc1
    v_pk_mul_f32 v[12:13], v[12:13], v[76:77]
    v_pk_mul_f32 v[14:15], v[14:15], v[78:79]
    v_pk_mul_f32 v[28:29], v[28:29], v[92:93]
    v_pk_mul_f32 v[30:31], v[30:31], v[94:95]
    v_pk_fma_f32 v[12:13], v[12:13], s[80:81], v[172:173]
    v_pk_fma_f32 v[14:15], v[14:15], s[80:81], v[174:175]
    v_pk_fma_f32 v[28:29], v[28:29], s[80:81], v[188:189]
    v_pk_fma_f32 v[30:31], v[30:31], s[80:81], v[190:191]
    v_cvt_pk_bf16_f32 v44, v12, v28
    ds_write_b32 v251, v44 offset:4960
    v_cvt_pk_bf16_f32 v45, v13, v29
    ds_write_b32 v251, v45 offset:5088
    v_cvt_pk_bf16_f32 v46, v14, v30
    ds_write_b32 v251, v46 offset:5216
    v_cvt_pk_bf16_f32 v47, v15, v31
    ds_write_b32 v251, v47 offset:5344
    ds_read_b128 v[60:63], v253 offset:4960
    s_waitcnt lgkmcnt(0)
    buffer_store_dwordx4 v[60:63], v252, s[20:23], s59 offen offset:2048 sc1
K2_G4:
K2_END:
    s_endpgm
.section .rodata,"a"
.p2align 6
.amdhsa_kernel gather_scatter__cheap_equivariant_egnn__graph_kernel
  .amdhsa_next_free_vgpr 256
  .amdhsa_next_free_sgpr 102
  .amdhsa_accum_offset 256
  .amdhsa_group_segment_fixed_size 0
  .amdhsa_kernarg_size 88
  .amdhsa_user_sgpr_count 2
  .amdhsa_user_sgpr_kernarg_segment_ptr 1
  .amdhsa_system_sgpr_workgroup_id_x 1
  .amdhsa_float_denorm_mode_32 3
.end_amdhsa_kernel
```
